```python
import torch

def _softmax(x, axis=-1):
    return torch.softmax(x, dim=axis)
def _gelu(x):
    return torch.nn.functional.gelu(x, approximate="tanh")
def _silu(x):
    return torch.nn.functional.silu(x)
def _sigmoid(x):
    return torch.sigmoid(x)
def _layernorm(x, axis=-1, eps=1e-5):
    m = x.mean(dim=axis, keepdim=True)
    v = x.var(dim=axis, keepdim=True, unbiased=False)
    return (x - m) / torch.sqrt(v + eps)
def _scatter_add(tgt, idx, src, axis=0):
    return tgt.clone().index_add_(axis, idx, src)
def _segment_sum(src, seg, n):
    out = torch.zeros((n,) + src.shape[1:], dtype=src.dtype)
    return out.index_add_(0, seg, src)
def _pad(x, pw):
    flat = tuple(v for pair in reversed(pw) for v in pair)
    return torch.nn.functional.pad(x, flat)

kernel_name = 'sequential_preLN__softmax_full_mha__dense_activation_silu__prompt'

def setup_inputs():

    _w = (lambda a: (lambda t: t.to(torch.bfloat16) if t.is_floating_point() else t)(torch.as_tensor(a)))
    def _A_setup():
        B, S, D = 1, 2048, 448
        return {
            "x": _w((lambda *s: torch.randn(*s, dtype=torch.bfloat16) * 0.05)(B, S, D)),
            "wqkv": _w((lambda *s: torch.randn(*s, dtype=torch.bfloat16) * 0.05)(D, 3 * D)),
            "wo": _w((lambda *s: torch.randn(*s, dtype=torch.bfloat16) * 0.05)(D, D)),
        }
    _A_in = _A_setup()

    def _B_setup():
        B, S, D, F = 1, 2048, 448, 1792
        return {
            "x": _w((lambda *s: torch.randn(*s, dtype=torch.bfloat16) * 0.05)(B, S, D)),
            "w1": _w((lambda *s: torch.randn(*s, dtype=torch.bfloat16) * 0.8)(D, F) * (D ** -0.5)),
            "w2": _w((lambda *s: torch.randn(*s, dtype=torch.bfloat16) * 0.2)(F, D) * (F ** -0.5)),
        }
    _B_in = _B_setup()

    return {
        "A_x": _A_in["x"],
        "A_wqkv": _A_in["wqkv"],
        "A_wo": _A_in["wo"],
        "B_x": _B_in["x"],
        "B_w1": _B_in["w1"],
        "B_w2": _B_in["w2"],
    }

def reference(A_x, A_wqkv, A_wo, B_x, B_w1, B_w2):
    def _A_ref(x, wqkv, wo):
        B, S, D = x.shape
        H = 16; Dh = D // H
        qkv = (lambda x, *d: x.permute(*d))((x @ wqkv).reshape(B, S, 3, H, Dh), 2, 0, 3, 1, 4)
        q, k, v = qkv[0], qkv[1], qkv[2]
        scale = Dh ** -0.5
        scores = torch.einsum("bhqd,bhkd->bhqk", q, k) * scale
        p = _softmax(scores, axis=-1)
        o = torch.einsum("bhqk,bhkd->bhqd", p, v)
        return (lambda x, *d: x.permute(*d))(o, 0, 2, 1, 3).reshape(B, S, D) @ wo

    def _B_ref(x, w1, w2):
        h = torch.einsum("bsd,df->bsf", x, w1)
        h = _silu(h)
        out = torch.einsum("bsf,fd->bsd", h, w2)
        return out

    x = A_x
    h = x + _A_ref(_layernorm(x, axis=-1), A_wqkv, A_wo)
    h2 = h + _B_ref(_layernorm(h, axis=-1), B_w1, B_w2)
    return h2
```

```asm
; @launch kernel=mega_kernel grid=(256,1,1) block=(512,1,1) lds=163840
.amdgcn_target "amdgcn-amd-amdhsa--gfx950"
.text
.globl mega_kernel
.p2align 8
.type mega_kernel,@function
mega_kernel:
  s_cmp_ge_u32 s2, 256
  s_cbranch_scc1 L_m_end
  s_load_dwordx2 s[4:5], s[0:1], 0
  s_load_dwordx2 s[56:57], s[0:1], 8
  s_load_dwordx2 s[6:7], s[0:1], 64
  s_load_dwordx2 s[58:59], s[0:1], 56
  s_load_dwordx2 s[8:9], s[0:1], 16
  s_load_dwordx2 s[10:11], s[0:1], 32
  s_load_dwordx4 s[12:15], s[0:1], 40
  v_lshrrev_b32 v9, 6, v0
  v_and_b32 v1, 63, v0
  v_and_b32 v2, 31, v0
  v_bfe_u32 v3, v0, 5, 1
  v_readfirstlane_b32 s3, v9
  v_lshlrev_b32 v4, 4, v1
  s_and_b32 s92, s2, 7
  s_lshr_b32 s61, s2, 3
  s_mov_b32 s100, 0x10000
  s_mov_b32 s60, 0
  s_cmp_ge_u32 s3, 4
  s_cbranch_scc1 L_m_load
  s_barrier
  s_barrier
  s_setprio 2
  s_lshl_b32 s27, s92, 1
  s_and_b32 s28, s61, 1
  s_add_u32 s27, s27, s28
  s_lshr_b32 s26, s61, 1
  s_lshr_b32 s93, s2, 3
  s_cmp_lt_u32 s93, 4
  s_cselect_b32 s101, 1, 0
  s_cselect_b32 s28, 0, 4
  s_sub_u32 s93, s93, s28
  s_and_b32 s94, s93, 1
  s_lshl_b32 s28, s92, 1
  s_add_u32 s94, s94, s28
  s_bfe_u32 s95, s93, 0x10001
  s_lshr_b32 s96, s93, 2
  s_lshr_b32 s97, s93, 1
  s_lshl_b32 s98, s94, 10
  s_add_u32 s98, s98, 0x7f8000
  s_mov_b32 s34, 0
  s_mov_b32 s35, -1
  s_and_b32 s28, s3, 1
  s_lshr_b32 s29, s3, 1
  v_mov_b32 v9, 159744
  v_mov_b32 v10, 0
  ds_write_b32 v9, v10
  v_lshlrev_b32 v9, 2, v0
  v_add_u32 v9, 155648, v9
  ds_write_b32 v9, v10
  s_and_b32 s36, s61, 1
  s_lshl_b32 s53, s26, 2
  s_add_u32 s53, s53, s3
  s_lshl_b32 s48, s92, 19
  s_lshl_b32 s49, s53, 12
  s_add_u32 s48, s48, s49
  s_lshl_b32 s49, s36, 11
  s_add_u32 s48, s48, s49
  s_add_u32 s48, s48, 0x200000
  s_add_u32 s49, s48, 0x40000
  s_lshl_b32 s50, s92, 10
  s_lshl_b32 s53, s3, 7
  s_add_u32 s50, s50, s53
  s_lshl_b32 s53, s36, 6
  s_add_u32 s50, s50, s53
  s_lshl_b32 s53, s26, 2
  s_add_u32 s50, s50, s53
  s_add_u32 s50, s50, 0x7fe000
  s_lshl_b32 s51, s27, 9
  s_lshl_b32 s53, s3, 7
  s_add_u32 s51, s51, s53
  s_add_u32 s51, s51, 0x7fe000
  v_and_b32 v47, 1, v1
  v_lshlrev_b32 v47, 9, v47
  v_and_b32 v6, 15, v1
  v_bfe_u32 v7, v1, 4, 1
  v_lshlrev_b32 v7, 18, v7
  v_lshl_add_u32 v46, v6, 7, v7
  v_mov_b32 v224, 0
  v_mov_b32 v225, 0
  v_mov_b32 v226, 0
  v_mov_b32 v227, 0
  s_lshl_b32 s52, s2, 12
  s_add_u32 s52, s52, 0x7f8000
  s_lshr_b32 s37, s2, 3
  s_or_b32 s37, s3, s37
  s_waitcnt lgkmcnt(0)
  s_mov_b32 s20, s6
  s_mov_b32 s21, s7
  s_mov_b32 s22, 0x2000000
  s_mov_b32 s23, 0x00020000
  s_cmp_lg_u32 s37, 0
  s_cbranch_scc1 L_m_nozero
  buffer_store_dwordx4 v[224:227], v4, s[20:23], s52 offen offset:0 sc1
  buffer_store_dwordx4 v[224:227], v4, s[20:23], s52 offen offset:1024 sc1
  buffer_store_dwordx4 v[224:227], v4, s[20:23], s52 offen offset:2048 sc1
  buffer_store_dwordx4 v[224:227], v4, s[20:23], s52 offen offset:3072 sc1
  s_mov_b32 s44, s58
  s_mov_b32 s45, s59
  s_mov_b32 s46, 0x100
  s_mov_b32 s47, 0x00020000
  s_getreg_b32 s52, hwreg(HW_REG_XCC_ID, 0, 4)
  s_or_b32 s52, s52, 16
  v_mov_b32 v229, s52
  v_mov_b32 v230, s92
  s_waitcnt vmcnt(0)
  s_mov_b64 exec, 1
  buffer_store_byte v229, v230, s[44:47], 0 offen sc1
  s_mov_b64 exec, -1
L_m_nozero:
  s_add_u32 s52, s26, s92
  s_mul_i32 s53, s52, 37
  s_lshr_b32 s53, s53, 8
  s_mul_i32 s53, s53, 7
  s_sub_u32 s52, s52, s53
  s_mov_b32 s44, s4
  s_mov_b32 s45, s5
  s_mov_b32 s46, 0x1c0000
  s_mov_b32 s47, 0x00020000
  s_lshl_b32 s53, s26, 2
  s_add_u32 s53, s53, s3
  s_mul_i32 s53, s53, 28672
  v_mul_u32_u24 v6, 896, v2
  s_mov_b32 s44, s56
  s_mov_b32 s45, s57
  s_mov_b32 s46, 0x126000
  s_mov_b32 s47, 0x00020000
  v_min_u32 v7, 27, v1
  v_lshrrev_b32 v8, 1, v7
  v_mul_u32_u24 v8, 2688, v8
  v_and_b32 v7, 1, v7
  v_mul_u32_u24 v7, 108, v7
  v_add_u32 v7, v7, v8
  s_lshr_b32 s52, s2, 3
  s_mul_i32 s52, s52, 37632
  s_and_b32 s53, s92, 7
  s_mul_i32 s53, s53, 112
  s_add_u32 s52, s52, s53
  s_cmp_lg_u32 s3, 1
  s_cbranch_scc1 L_m_noqt
  buffer_load_dword v111, v7, s[44:47], s52 offen
L_m_noqt:
  s_lshl_b32 s52, s3, 12
  v_lshlrev_b32 v6, 7, v2
  v_add_u32 v6, s52, v6
  v_bfe_u32 v7, v2, 1, 3
  v_xor_b32 v7, v7, v3
  v_bfe_u32 v8, v1, 2, 2
  v_lshl_add_u32 v8, v3, 3, v8
  v_bfe_u32 v9, v1, 4, 1
  v_lshlrev_b32 v9, 5, v9
  v_and_b32 v10, 3, v1
  v_lshl_add_u32 v9, v10, 3, v9
  s_lshl_b32 s53, s36, 3
  s_add_u32 s53, s53, 16384
  v_lshl_add_u32 v32, v8, 6, v9
  v_add_u32 v36, s53, v32
  v_bfe_u32 v10, v1, 3, 1
  v_lshlrev_b32 v10, 6, v10
  v_add_u32 v37, 56, v9
  v_xor_b32 v9, v9, v10
  v_xor_b32 v10, v37, v10
  v_lshl_add_u32 v9, v8, 7, v9
  v_lshl_add_u32 v10, v8, 7, v10
  s_xor_b32 s52, s3, 0
  s_lshl_b32 s53, s52, 1
  v_xor_b32 v8, s53, v7
  v_lshl_add_u32 v16, v8, 4, v6
  v_add_u32 v20, 65536, v16
  s_lshl_b32 s53, s52, 11
  s_add_u32 s53, s53, 98304
  v_add_u32 v24, s53, v9
  v_add_u32 v28, s53, v10
  s_lshl_b32 s53, s52, 10
  v_add_u32 v32, s53, v36
  s_xor_b32 s52, s3, 1
  s_lshl_b32 s53, s52, 1
  v_xor_b32 v8, s53, v7
  v_lshl_add_u32 v17, v8, 4, v6
  v_add_u32 v21, 65536, v17
  s_lshl_b32 s53, s52, 11
  s_add_u32 s53, s53, 98304
  v_add_u32 v25, s53, v9
  v_add_u32 v29, s53, v10
  s_lshl_b32 s53, s52, 10
  v_add_u32 v33, s53, v36
  s_xor_b32 s52, s3, 2
  s_lshl_b32 s53, s52, 1
  v_xor_b32 v8, s53, v7
  v_lshl_add_u32 v18, v8, 4, v6
  v_add_u32 v22, 65536, v18
  s_lshl_b32 s53, s52, 11
  s_add_u32 s53, s53, 98304
  v_add_u32 v26, s53, v9
  v_add_u32 v30, s53, v10
  s_lshl_b32 s53, s52, 10
  v_add_u32 v34, s53, v36
  s_xor_b32 s52, s3, 3
  s_lshl_b32 s53, s52, 1
  v_xor_b32 v8, s53, v7
  v_lshl_add_u32 v19, v8, 4, v6
  v_add_u32 v23, 65536, v19
  s_lshl_b32 s53, s52, 11
  s_add_u32 s53, s53, 98304
  v_add_u32 v27, s53, v9
  v_add_u32 v31, s53, v10
  s_lshl_b32 s53, s52, 10
  v_add_u32 v35, s53, v36
  v_bfe_u32 v9, v1, 4, 1
  v_xor_b32 v9, v9, v1
  v_and_b32 v9, 1, v9
  v_cmp_eq_u32 vcc, 0, v9
  v_mov_b32 v9, 0x3f803f80
  v_cndmask_b32 v36, 0, v9, vcc
  v_cndmask_b32 v37, 0, v9, vcc
  v_cndmask_b32 v38, 0, v9, vcc
  v_cndmask_b32 v39, 0, v9, vcc
  v_mov_b32 v44, 0x3f80
  v_cmp_eq_u32 vcc, 28, v2
  v_cndmask_b32 v45, 0, v9, vcc
  s_add_u32 s40, s3, 1
  s_and_b32 s40, s40, 3
  s_add_u32 s41, s3, 2
  s_and_b32 s41, s41, 3
  s_add_u32 s42, s3, 3
  s_and_b32 s42, s42, 3
  s_add_u32 s43, s3, 4
  s_and_b32 s43, s43, 3
  s_lshl_b32 s54, s27, 6
  s_add_u32 s54, s54, s3
  s_lshl_b32 s54, s54, 12
  s_add_u32 s54, s54, 0x200000
  s_mul_i32 s52, s40, 12288
  s_add_u32 s52, s52, 0
  v_add_u32 v11, s52, v4
  s_mul_i32 s52, s41, 12288
  s_add_u32 s52, s52, 4096
  v_add_u32 v12, s52, v4
  s_mul_i32 s52, s42, 12288
  s_add_u32 s52, s52, 8192
  v_add_u32 v13, s52, v4
  s_mul_i32 s52, s3, 12288
  v_add_u32 v14, s52, v4
  v_bfe_u32 v8, v1, 2, 2
  v_lshl_add_u32 v8, v3, 2, v8
  v_lshlrev_b32 v8, 7, v8
  v_bfe_u32 v9, v1, 4, 1
  v_lshl_add_u32 v8, v9, 5, v8
  v_and_b32 v9, 3, v1
  v_lshl_add_u32 v8, v9, 3, v8
  v_bfe_u32 v9, v1, 3, 1
  v_xor_b32 v5, s29, v9
  v_lshl_add_u32 v5, v5, 6, v8
  s_lshl_b32 s30, s94, 2
  s_lshl_b32 s31, s95, 1
  s_add_u32 s30, s30, s31
  s_add_u32 s30, s30, s28
  s_lshl_b32 s31, s96, 1
  s_add_u32 s31, s31, s29
  s_mul_i32 s32, s30, 28672
  s_lshl_b32 s33, s31, 6
  s_add_u32 s32, s32, s33
  v_lshlrev_b32 v15, 2, v2
  s_lshl_b32 s52, s3, 7
  s_add_u32 s52, s52, 156672
  v_lshl_add_u32 v102, v2, 2, s52
  v_lshl_add_u32 v103, v3, 4, s52
  s_mov_b32 s52, 155648
  v_lshl_add_u32 v101, v2, 2, s52
  v_lshl_add_u32 v100, v3, 4, s52
  v_cmp_le_u32 s[62:63], 28, v2
  v_mov_b32 v10, 159748
  s_lshl_b32 s52, s3, 11
  v_add_u32 v6, s52, v4
  s_lshl_b32 s52, s40, 11
  v_add_u32 v7, s52, v4
  s_lshl_b32 s52, s41, 11
  v_add_u32 v8, s52, v4
  s_lshl_b32 s52, s42, 11
  v_add_u32 v9, s52, v4
  s_waitcnt lgkmcnt(0)
  s_barrier
  ds_read_b128 v[112:115], v16 offset:0
  ds_read_b64_tr_b16 v[224:225], v24 offset:0
  ds_read_b64_tr_b16 v[226:227], v24 offset:512
  ds_read_b64_tr_b16 v[228:229], v28 offset:0
  ds_read_b64_tr_b16 v[230:231], v28 offset:512
  ds_read_b128 v[116:119], v17 offset:0
  ds_read_b64_tr_b16 v[232:233], v25 offset:0
  ds_read_b64_tr_b16 v[234:235], v25 offset:512
  ds_read_b64_tr_b16 v[236:237], v29 offset:0
  ds_read_b64_tr_b16 v[238:239], v29 offset:512
  s_cmp_lg_u32 s36, 0
  s_cbranch_scc1 L_m_pv
  s_waitcnt lgkmcnt(5)
  v_mfma_f32_32x32x16_bf16 v[80:95], v[112:115], v[112:115], 0
  ds_read_b128 v[120:123], v18 offset:0
  ds_read_b64_tr_b16 v[240:241], v26 offset:0
  v_mfma_f32_16x16x32_bf16 v[96:99], v[36:39], v[112:115], 0
  ds_read_b64_tr_b16 v[242:243], v26 offset:512
  v_mfma_f32_32x32x16_bf16 v[48:63], v[224:227], v[112:115], 0
  ds_read_b64_tr_b16 v[244:245], v30 offset:0
  ds_read_b64_tr_b16 v[246:247], v30 offset:512
  v_mfma_f32_32x32x16_bf16 v[64:79], v[228:231], v[112:115], 0
  s_waitcnt lgkmcnt(5)
  v_mfma_f32_32x32x16_bf16 v[80:95], v[116:119], v[116:119], v[80:95]
  ds_read_b128 v[124:127], v19 offset:0
  ds_read_b64_tr_b16 v[248:249], v27 offset:0
  v_mfma_f32_16x16x32_bf16 v[96:99], v[36:39], v[116:119], v[96:99]
  ds_read_b64_tr_b16 v[250:251], v27 offset:512
  v_mfma_f32_32x32x16_bf16 v[48:63], v[232:235], v[116:119], v[48:63]
  ds_read_b64_tr_b16 v[252:253], v31 offset:0
  ds_read_b64_tr_b16 v[254:255], v31 offset:512
  v_mfma_f32_32x32x16_bf16 v[64:79], v[236:239], v[116:119], v[64:79]
  s_barrier
  s_waitcnt lgkmcnt(5)
  v_mfma_f32_32x32x16_bf16 v[80:95], v[120:123], v[120:123], v[80:95]
  ds_read_b128 v[128:131], v16 offset:16384
  ds_read_b64_tr_b16 v[224:225], v24 offset:8192
  v_mfma_f32_16x16x32_bf16 v[96:99], v[36:39], v[120:123], v[96:99]
  ds_read_b64_tr_b16 v[226:227], v24 offset:8704
  v_mfma_f32_32x32x16_bf16 v[48:63], v[240:243], v[120:123], v[48:63]
  ds_read_b64_tr_b16 v[228:229], v28 offset:8192
  ds_read_b64_tr_b16 v[230:231], v28 offset:8704
  v_mfma_f32_32x32x16_bf16 v[64:79], v[244:247], v[120:123], v[64:79]
  s_waitcnt lgkmcnt(5)
  v_mfma_f32_32x32x16_bf16 v[80:95], v[124:127], v[124:127], v[80:95]
  ds_read_b128 v[132:135], v17 offset:16384
  ds_read_b64_tr_b16 v[232:233], v25 offset:8192
  v_mfma_f32_16x16x32_bf16 v[96:99], v[36:39], v[124:127], v[96:99]
  ds_read_b64_tr_b16 v[234:235], v25 offset:8704
  v_mfma_f32_32x32x16_bf16 v[48:63], v[248:251], v[124:127], v[48:63]
  ds_read_b64_tr_b16 v[236:237], v29 offset:8192
  ds_read_b64_tr_b16 v[238:239], v29 offset:8704
  v_mfma_f32_32x32x16_bf16 v[64:79], v[252:255], v[124:127], v[64:79]
  s_waitcnt lgkmcnt(5)
  v_mfma_f32_32x32x16_bf16 v[80:95], v[128:131], v[128:131], v[80:95]
  ds_read_b128 v[136:139], v18 offset:16384
  ds_read_b64_tr_b16 v[240:241], v26 offset:8192
  v_mfma_f32_16x16x32_bf16 v[96:99], v[36:39], v[128:131], v[96:99]
  ds_read_b64_tr_b16 v[242:243], v26 offset:8704
  v_mfma_f32_32x32x16_bf16 v[48:63], v[224:227], v[128:131], v[48:63]
  ds_read_b64_tr_b16 v[244:245], v30 offset:8192
  ds_read_b64_tr_b16 v[246:247], v30 offset:8704
  v_mfma_f32_32x32x16_bf16 v[64:79], v[228:231], v[128:131], v[64:79]
  s_waitcnt lgkmcnt(5)
  v_mfma_f32_32x32x16_bf16 v[80:95], v[132:135], v[132:135], v[80:95]
  ds_read_b128 v[140:143], v19 offset:16384
  ds_read_b64_tr_b16 v[248:249], v27 offset:8192
  v_mfma_f32_16x16x32_bf16 v[96:99], v[36:39], v[132:135], v[96:99]
  ds_read_b64_tr_b16 v[250:251], v27 offset:8704
  v_mfma_f32_32x32x16_bf16 v[48:63], v[232:235], v[132:135], v[48:63]
  ds_read_b64_tr_b16 v[252:253], v31 offset:8192
  ds_read_b64_tr_b16 v[254:255], v31 offset:8704
  v_mfma_f32_32x32x16_bf16 v[64:79], v[236:239], v[132:135], v[64:79]
  s_barrier
  s_waitcnt lgkmcnt(5)
  v_mfma_f32_32x32x16_bf16 v[80:95], v[136:139], v[136:139], v[80:95]
  ds_read_b128 v[144:147], v16 offset:32768
  ds_read_b64_tr_b16 v[224:225], v24 offset:16384
  v_mfma_f32_16x16x32_bf16 v[96:99], v[36:39], v[136:139], v[96:99]
  ds_read_b64_tr_b16 v[226:227], v24 offset:16896
  v_mfma_f32_32x32x16_bf16 v[48:63], v[240:243], v[136:139], v[48:63]
  ds_read_b64_tr_b16 v[228:229], v28 offset:16384
  ds_read_b64_tr_b16 v[230:231], v28 offset:16896
  v_mfma_f32_32x32x16_bf16 v[64:79], v[244:247], v[136:139], v[64:79]
  s_waitcnt lgkmcnt(5)
  v_mfma_f32_32x32x16_bf16 v[80:95], v[140:143], v[140:143], v[80:95]
  ds_read_b128 v[148:151], v17 offset:32768
  ds_read_b64_tr_b16 v[232:233], v25 offset:16384
  v_mfma_f32_16x16x32_bf16 v[96:99], v[36:39], v[140:143], v[96:99]
  ds_read_b64_tr_b16 v[234:235], v25 offset:16896
  v_mfma_f32_32x32x16_bf16 v[48:63], v[248:251], v[140:143], v[48:63]
  ds_read_b64_tr_b16 v[236:237], v29 offset:16384
  ds_read_b64_tr_b16 v[238:239], v29 offset:16896
  v_mfma_f32_32x32x16_bf16 v[64:79], v[252:255], v[140:143], v[64:79]
  s_waitcnt lgkmcnt(5)
  v_mfma_f32_32x32x16_bf16 v[80:95], v[144:147], v[144:147], v[80:95]
  ds_read_b128 v[152:155], v18 offset:32768
  ds_read_b64_tr_b16 v[240:241], v26 offset:16384
  v_mfma_f32_16x16x32_bf16 v[96:99], v[36:39], v[144:147], v[96:99]
  ds_read_b64_tr_b16 v[242:243], v26 offset:16896
  v_mfma_f32_32x32x16_bf16 v[48:63], v[224:227], v[144:147], v[48:63]
  ds_read_b64_tr_b16 v[244:245], v30 offset:16384
  ds_read_b64_tr_b16 v[246:247], v30 offset:16896
  v_mfma_f32_32x32x16_bf16 v[64:79], v[228:231], v[144:147], v[64:79]
  s_waitcnt lgkmcnt(5)
  v_mfma_f32_32x32x16_bf16 v[80:95], v[148:151], v[148:151], v[80:95]
  ds_read_b128 v[156:159], v19 offset:32768
  ds_read_b64_tr_b16 v[248:249], v27 offset:16384
  v_mfma_f32_16x16x32_bf16 v[96:99], v[36:39], v[148:151], v[96:99]
  ds_read_b64_tr_b16 v[250:251], v27 offset:16896
  v_mfma_f32_32x32x16_bf16 v[48:63], v[232:235], v[148:151], v[48:63]
  ds_read_b64_tr_b16 v[252:253], v31 offset:16384
  ds_read_b64_tr_b16 v[254:255], v31 offset:16896
  v_mfma_f32_32x32x16_bf16 v[64:79], v[236:239], v[148:151], v[64:79]
  s_barrier
  s_waitcnt lgkmcnt(5)
  v_mfma_f32_32x32x16_bf16 v[80:95], v[152:155], v[152:155], v[80:95]
  ds_read_b128 v[160:163], v16 offset:49152
  ds_read_b64_tr_b16 v[224:225], v24 offset:24576
  v_mfma_f32_16x16x32_bf16 v[96:99], v[36:39], v[152:155], v[96:99]
  ds_read_b64_tr_b16 v[226:227], v24 offset:25088
  v_mfma_f32_32x32x16_bf16 v[48:63], v[240:243], v[152:155], v[48:63]
  ds_read_b64_tr_b16 v[228:229], v28 offset:24576
  ds_read_b64_tr_b16 v[230:231], v28 offset:25088
  v_mfma_f32_32x32x16_bf16 v[64:79], v[244:247], v[152:155], v[64:79]
  s_waitcnt lgkmcnt(5)
  v_mfma_f32_32x32x16_bf16 v[80:95], v[156:159], v[156:159], v[80:95]
  ds_read_b128 v[164:167], v17 offset:49152
  ds_read_b64_tr_b16 v[232:233], v25 offset:24576
  v_mfma_f32_16x16x32_bf16 v[96:99], v[36:39], v[156:159], v[96:99]
  ds_read_b64_tr_b16 v[234:235], v25 offset:25088
  v_mfma_f32_32x32x16_bf16 v[48:63], v[248:251], v[156:159], v[48:63]
  ds_read_b64_tr_b16 v[236:237], v29 offset:24576
  ds_read_b64_tr_b16 v[238:239], v29 offset:25088
  v_mfma_f32_32x32x16_bf16 v[64:79], v[252:255], v[156:159], v[64:79]
  s_waitcnt lgkmcnt(5)
  v_mfma_f32_32x32x16_bf16 v[80:95], v[160:163], v[160:163], v[80:95]
  ds_read_b128 v[168:171], v18 offset:49152
  ds_read_b64_tr_b16 v[240:241], v26 offset:24576
  v_mfma_f32_16x16x32_bf16 v[96:99], v[36:39], v[160:163], v[96:99]
  ds_read_b64_tr_b16 v[242:243], v26 offset:25088
  v_mfma_f32_32x32x16_bf16 v[48:63], v[224:227], v[160:163], v[48:63]
  ds_read_b64_tr_b16 v[244:245], v30 offset:24576
  ds_read_b64_tr_b16 v[246:247], v30 offset:25088
  v_mfma_f32_32x32x16_bf16 v[64:79], v[228:231], v[160:163], v[64:79]
  s_waitcnt lgkmcnt(5)
  v_mfma_f32_32x32x16_bf16 v[80:95], v[164:167], v[164:167], v[80:95]
  ds_read_b128 v[172:175], v19 offset:49152
  ds_read_b64_tr_b16 v[248:249], v27 offset:24576
  v_mfma_f32_16x16x32_bf16 v[96:99], v[36:39], v[164:167], v[96:99]
  ds_read_b64_tr_b16 v[250:251], v27 offset:25088
  v_mfma_f32_32x32x16_bf16 v[48:63], v[232:235], v[164:167], v[48:63]
  ds_read_b64_tr_b16 v[252:253], v31 offset:24576
  ds_read_b64_tr_b16 v[254:255], v31 offset:25088
  v_mfma_f32_32x32x16_bf16 v[64:79], v[236:239], v[164:167], v[64:79]
  s_barrier
  s_waitcnt lgkmcnt(5)
  v_mfma_f32_32x32x16_bf16 v[80:95], v[168:171], v[168:171], v[80:95]
  ds_read_b128 v[176:179], v20 offset:0
  ds_read_b64_tr_b16 v[224:225], v24 offset:32768
  v_mfma_f32_16x16x32_bf16 v[96:99], v[36:39], v[168:171], v[96:99]
  ds_read_b64_tr_b16 v[226:227], v24 offset:33280
  v_mfma_f32_32x32x16_bf16 v[48:63], v[240:243], v[168:171], v[48:63]
  ds_read_b64_tr_b16 v[228:229], v28 offset:32768
  ds_read_b64_tr_b16 v[230:231], v28 offset:33280
  v_mfma_f32_32x32x16_bf16 v[64:79], v[244:247], v[168:171], v[64:79]
  s_waitcnt lgkmcnt(5)
  v_mfma_f32_32x32x16_bf16 v[80:95], v[172:175], v[172:175], v[80:95]
  ds_read_b128 v[180:183], v21 offset:0
  ds_read_b64_tr_b16 v[232:233], v25 offset:32768
  v_mfma_f32_16x16x32_bf16 v[96:99], v[36:39], v[172:175], v[96:99]
  ds_read_b64_tr_b16 v[234:235], v25 offset:33280
  v_mfma_f32_32x32x16_bf16 v[48:63], v[248:251], v[172:175], v[48:63]
  ds_read_b64_tr_b16 v[236:237], v29 offset:32768
  ds_read_b64_tr_b16 v[238:239], v29 offset:33280
  v_mfma_f32_32x32x16_bf16 v[64:79], v[252:255], v[172:175], v[64:79]
  s_waitcnt lgkmcnt(5)
  v_mfma_f32_32x32x16_bf16 v[80:95], v[176:179], v[176:179], v[80:95]
  ds_read_b128 v[184:187], v22 offset:0
  ds_read_b64_tr_b16 v[240:241], v26 offset:32768
  v_mfma_f32_16x16x32_bf16 v[96:99], v[36:39], v[176:179], v[96:99]
  ds_read_b64_tr_b16 v[242:243], v26 offset:33280
  v_mfma_f32_32x32x16_bf16 v[48:63], v[224:227], v[176:179], v[48:63]
  ds_read_b64_tr_b16 v[244:245], v30 offset:32768
  ds_read_b64_tr_b16 v[246:247], v30 offset:33280
  v_mfma_f32_32x32x16_bf16 v[64:79], v[228:231], v[176:179], v[64:79]
  s_waitcnt lgkmcnt(5)
  v_mfma_f32_32x32x16_bf16 v[80:95], v[180:183], v[180:183], v[80:95]
  ds_read_b128 v[188:191], v23 offset:0
  ds_read_b64_tr_b16 v[248:249], v27 offset:32768
  v_mfma_f32_16x16x32_bf16 v[96:99], v[36:39], v[180:183], v[96:99]
  ds_read_b64_tr_b16 v[250:251], v27 offset:33280
  v_mfma_f32_32x32x16_bf16 v[48:63], v[232:235], v[180:183], v[48:63]
  ds_read_b64_tr_b16 v[252:253], v31 offset:32768
  ds_read_b64_tr_b16 v[254:255], v31 offset:33280
  v_mfma_f32_32x32x16_bf16 v[64:79], v[236:239], v[180:183], v[64:79]
  s_barrier
  buffer_load_dword v46, v46, s[20:23], s48 offen
  s_waitcnt lgkmcnt(5)
  v_mfma_f32_32x32x16_bf16 v[80:95], v[184:187], v[184:187], v[80:95]
  ds_read_b128 v[192:195], v20 offset:16384
  ds_read_b64_tr_b16 v[224:225], v24 offset:40960
  v_mfma_f32_16x16x32_bf16 v[96:99], v[36:39], v[184:187], v[96:99]
  ds_read_b64_tr_b16 v[226:227], v24 offset:41472
  v_mfma_f32_32x32x16_bf16 v[48:63], v[240:243], v[184:187], v[48:63]
  ds_read_b64_tr_b16 v[228:229], v28 offset:40960
  ds_read_b64_tr_b16 v[230:231], v28 offset:41472
  v_mfma_f32_32x32x16_bf16 v[64:79], v[244:247], v[184:187], v[64:79]
  s_waitcnt lgkmcnt(5)
  v_mfma_f32_32x32x16_bf16 v[80:95], v[188:191], v[188:191], v[80:95]
  ds_read_b128 v[196:199], v21 offset:16384
  ds_read_b64_tr_b16 v[232:233], v25 offset:40960
  v_mfma_f32_16x16x32_bf16 v[96:99], v[36:39], v[188:191], v[96:99]
  ds_read_b64_tr_b16 v[234:235], v25 offset:41472
  v_mfma_f32_32x32x16_bf16 v[48:63], v[248:251], v[188:191], v[48:63]
  ds_read_b64_tr_b16 v[236:237], v29 offset:40960
  ds_read_b64_tr_b16 v[238:239], v29 offset:41472
  v_mfma_f32_32x32x16_bf16 v[64:79], v[252:255], v[188:191], v[64:79]
  s_waitcnt lgkmcnt(5)
  v_mfma_f32_32x32x16_bf16 v[80:95], v[192:195], v[192:195], v[80:95]
  ds_read_b128 v[200:203], v22 offset:16384
  ds_read_b64_tr_b16 v[240:241], v26 offset:40960
  v_mfma_f32_16x16x32_bf16 v[96:99], v[36:39], v[192:195], v[96:99]
  ds_read_b64_tr_b16 v[242:243], v26 offset:41472
  v_mfma_f32_32x32x16_bf16 v[48:63], v[224:227], v[192:195], v[48:63]
  ds_read_b64_tr_b16 v[244:245], v30 offset:40960
  ds_read_b64_tr_b16 v[246:247], v30 offset:41472
  v_mfma_f32_32x32x16_bf16 v[64:79], v[228:231], v[192:195], v[64:79]
  s_waitcnt lgkmcnt(5)
  v_mfma_f32_32x32x16_bf16 v[80:95], v[196:199], v[196:199], v[80:95]
  ds_read_b128 v[204:207], v23 offset:16384
  ds_read_b64_tr_b16 v[248:249], v27 offset:40960
  v_mfma_f32_16x16x32_bf16 v[96:99], v[36:39], v[196:199], v[96:99]
  ds_read_b64_tr_b16 v[250:251], v27 offset:41472
  v_mfma_f32_32x32x16_bf16 v[48:63], v[232:235], v[196:199], v[48:63]
  ds_read_b64_tr_b16 v[252:253], v31 offset:40960
  ds_read_b64_tr_b16 v[254:255], v31 offset:41472
  v_mfma_f32_32x32x16_bf16 v[64:79], v[236:239], v[196:199], v[64:79]
  s_barrier
  s_waitcnt lgkmcnt(5)
  v_mfma_f32_32x32x16_bf16 v[80:95], v[200:203], v[200:203], v[80:95]
  ds_read_b128 v[208:211], v16 offset:0
  ds_read_b64_tr_b16 v[224:225], v24 offset:0
  v_mfma_f32_16x16x32_bf16 v[96:99], v[36:39], v[200:203], v[96:99]
  ds_read_b64_tr_b16 v[226:227], v24 offset:512
  v_mfma_f32_32x32x16_bf16 v[48:63], v[240:243], v[200:203], v[48:63]
  ds_read_b64_tr_b16 v[228:229], v28 offset:0
  ds_read_b64_tr_b16 v[230:231], v28 offset:512
  v_mfma_f32_32x32x16_bf16 v[64:79], v[244:247], v[200:203], v[64:79]
  s_waitcnt lgkmcnt(5)
  v_mfma_f32_32x32x16_bf16 v[80:95], v[204:207], v[204:207], v[80:95]
  ds_read_b128 v[212:215], v17 offset:0
  ds_read_b64_tr_b16 v[232:233], v25 offset:0
  v_mfma_f32_16x16x32_bf16 v[96:99], v[36:39], v[204:207], v[96:99]
  ds_read_b64_tr_b16 v[234:235], v25 offset:512
  v_mfma_f32_32x32x16_bf16 v[48:63], v[248:251], v[204:207], v[48:63]
  ds_read_b64_tr_b16 v[236:237], v29 offset:0
  ds_read_b64_tr_b16 v[238:239], v29 offset:512
  v_mfma_f32_32x32x16_bf16 v[64:79], v[252:255], v[204:207], v[64:79]
  s_waitcnt lgkmcnt(5)
  v_mfma_f32_32x32x16_bf16 v[80:95], v[208:211], v[208:211], v[80:95]
  ds_read_b128 v[216:219], v18 offset:0
  ds_read_b64_tr_b16 v[240:241], v26 offset:0
  v_mfma_f32_16x16x32_bf16 v[96:99], v[36:39], v[208:211], v[96:99]
  ds_read_b64_tr_b16 v[242:243], v26 offset:512
  v_mfma_f32_32x32x16_bf16 v[48:63], v[224:227], v[208:211], v[48:63]
  ds_read_b64_tr_b16 v[244:245], v30 offset:0
  ds_read_b64_tr_b16 v[246:247], v30 offset:512
  v_mfma_f32_32x32x16_bf16 v[64:79], v[228:231], v[208:211], v[64:79]
  s_waitcnt lgkmcnt(5)
  v_mfma_f32_32x32x16_bf16 v[80:95], v[212:215], v[212:215], v[80:95]
  ds_read_b128 v[220:223], v19 offset:0
  ds_read_b64_tr_b16 v[248:249], v27 offset:0
  v_mfma_f32_16x16x32_bf16 v[96:99], v[36:39], v[212:215], v[96:99]
  ds_read_b64_tr_b16 v[250:251], v27 offset:512
  v_mfma_f32_32x32x16_bf16 v[48:63], v[232:235], v[212:215], v[48:63]
  ds_read_b64_tr_b16 v[252:253], v31 offset:0
  ds_read_b64_tr_b16 v[254:255], v31 offset:512
  v_mfma_f32_32x32x16_bf16 v[64:79], v[236:239], v[212:215], v[64:79]
  s_waitcnt lgkmcnt(5)
  v_mfma_f32_32x32x16_bf16 v[80:95], v[216:219], v[216:219], v[80:95]
  v_mfma_f32_16x16x32_bf16 v[96:99], v[36:39], v[216:219], v[96:99]
  v_mfma_f32_32x32x16_bf16 v[48:63], v[240:243], v[216:219], v[48:63]
  v_mfma_f32_32x32x16_bf16 v[64:79], v[244:247], v[216:219], v[64:79]
  s_waitcnt lgkmcnt(0)
  v_mfma_f32_32x32x16_bf16 v[80:95], v[220:223], v[220:223], v[80:95]
  v_mfma_f32_16x16x32_bf16 v[96:99], v[36:39], v[220:223], v[96:99]
  v_mfma_f32_32x32x16_bf16 v[48:63], v[248:251], v[220:223], v[48:63]
  v_mfma_f32_32x32x16_bf16 v[64:79], v[252:255], v[220:223], v[64:79]
  s_mov_b32 s52, 0x3b124925
  s_mov_b32 s44, 0xaaaaaaaa
  s_mov_b32 s45, 0xaaaaaaaa
  s_mov_b32 s46, 0xcccccccc
  s_mov_b32 s47, 0xcccccccc
  s_mov_b32 s38, 0xff00ff00
  s_mov_b32 s39, 0xff00ff00
  s_mov_b32 vcc_lo, 0xffff0000
  s_mov_b32 vcc_hi, 0xffff0000
  s_mov_b32 s52, 0x3b124925
  v_cndmask_b32_e64 v80, v80, v81, s[44:45]
  v_cndmask_b32_e64 v82, v82, v83, s[44:45]
  v_cndmask_b32_e64 v84, v84, v85, s[44:45]
  v_cndmask_b32_e64 v86, v86, v87, s[44:45]
  v_cndmask_b32_e64 v88, v88, v89, s[44:45]
  v_cndmask_b32_e64 v90, v90, v91, s[44:45]
  v_cndmask_b32_e64 v92, v92, v93, s[44:45]
  v_cndmask_b32_e64 v94, v94, v95, s[44:45]
  v_cndmask_b32_e64 v80, v80, v82, s[46:47]
  v_cndmask_b32_e64 v84, v84, v86, s[46:47]
  v_cndmask_b32_e64 v88, v88, v90, s[46:47]
  v_cndmask_b32_e64 v92, v92, v94, s[46:47]
  v_cndmask_b32_e64 v80, v80, v84, s[38:39]
  v_cndmask_b32_e64 v88, v88, v92, s[38:39]
  v_cndmask_b32 v80, v80, v88, vcc
  v_cndmask_b32 v40, v96, v97, vcc
  v_mov_b32 v81, v80
  s_mov_b32 s44, 0xf0f0f0f0
  s_mov_b32 s45, 0xf0f0f0f0
  v_permlane32_swap_b32 v80, v81
  v_mul_f32 v40, s52, v40
  s_barrier
  ds_read_b128 v[224:227], v100 offset:0
  ds_read_b128 v[228:231], v100 offset:32
  ds_read_b128 v[232:235], v100 offset:64
  ds_read_b128 v[236:239], v100 offset:96
  ds_read_b128 v[240:243], v100 offset:128
  ds_read_b128 v[244:247], v100 offset:160
  ds_read_b128 v[248:251], v100 offset:192
  ds_read_b128 v[252:255], v100 offset:224
  ds_read_b32 v10, v10
  v_cndmask_b32_e64 v42, v80, v81, s[44:45]
  v_mul_f32 v42, s52, v42
  v_fma_f32 v42, -v40, v40, v42
  v_max_f32 v42, 0, v42
  v_cvt_pk_bf16_f32 v82, v40, v40
  v_lshlrev_b32 v40, 16, v82
  v_cvt_pk_bf16_f32 v82, v42, v42
  v_lshlrev_b32 v42, 16, v82
  v_add_f32 v42, 0x3727c5ac, v42
  v_cvt_pk_bf16_f32 v82, v42, v42
  v_lshlrev_b32 v42, 16, v82
  v_sqrt_f32 v42, v42
  s_nop 0
  v_cvt_pk_bf16_f32 v82, v42, v42
  v_lshlrev_b32 v42, 16, v82
  v_rcp_f32 v42, v42
  s_waitcnt lgkmcnt(5)
  v_pk_fma_f32 v[48:49], v[224:225], v[40:41], v[48:49] op_sel_hi:[1,0,1] neg_lo:[0,1,0] neg_hi:[0,1,0]
  v_pk_fma_f32 v[50:51], v[226:227], v[40:41], v[50:51] op_sel_hi:[1,0,1] neg_lo:[0,1,0] neg_hi:[0,1,0]
  v_pk_fma_f32 v[52:53], v[228:229], v[40:41], v[52:53] op_sel_hi:[1,0,1] neg_lo:[0,1,0] neg_hi:[0,1,0]
  v_pk_fma_f32 v[54:55], v[230:231], v[40:41], v[54:55] op_sel_hi:[1,0,1] neg_lo:[0,1,0] neg_hi:[0,1,0]
  v_pk_fma_f32 v[56:57], v[232:233], v[40:41], v[56:57] op_sel_hi:[1,0,1] neg_lo:[0,1,0] neg_hi:[0,1,0]
  v_pk_fma_f32 v[58:59], v[234:235], v[40:41], v[58:59] op_sel_hi:[1,0,1] neg_lo:[0,1,0] neg_hi:[0,1,0]
  v_pk_fma_f32 v[60:61], v[236:237], v[40:41], v[60:61] op_sel_hi:[1,0,1] neg_lo:[0,1,0] neg_hi:[0,1,0]
  v_pk_fma_f32 v[62:63], v[238:239], v[40:41], v[62:63] op_sel_hi:[1,0,1] neg_lo:[0,1,0] neg_hi:[0,1,0]
  v_pk_mul_f32 v[48:49], v[48:49], v[42:43] op_sel_hi:[1,0]
  v_pk_mul_f32 v[50:51], v[50:51], v[42:43] op_sel_hi:[1,0]
  v_pk_mul_f32 v[52:53], v[52:53], v[42:43] op_sel_hi:[1,0]
  v_pk_mul_f32 v[54:55], v[54:55], v[42:43] op_sel_hi:[1,0]
  v_pk_mul_f32 v[56:57], v[56:57], v[42:43] op_sel_hi:[1,0]
  v_pk_mul_f32 v[58:59], v[58:59], v[42:43] op_sel_hi:[1,0]
  v_pk_mul_f32 v[60:61], v[60:61], v[42:43] op_sel_hi:[1,0]
  v_pk_mul_f32 v[62:63], v[62:63], v[42:43] op_sel_hi:[1,0]
  v_cvt_pk_bf16_f32 v48, v48, v49
  v_cvt_pk_bf16_f32 v49, v50, v51
  v_cvt_pk_bf16_f32 v50, v52, v53
  v_cvt_pk_bf16_f32 v51, v54, v55
  v_cvt_pk_bf16_f32 v52, v56, v57
  v_cvt_pk_bf16_f32 v53, v58, v59
  v_cvt_pk_bf16_f32 v54, v60, v61
  v_cvt_pk_bf16_f32 v55, v62, v63
  v_cndmask_b32_e64 v54, v54, v44, s[34:35]
  v_cndmask_b32_e64 v55, v55, 0, s[34:35]
  buffer_store_dwordx4 v[48:51], v4, s[20:23], s48 offen
  buffer_store_dwordx4 v[52:55], v4, s[20:23], s48 offen offset:1024
  s_waitcnt lgkmcnt(1)
  v_pk_fma_f32 v[64:65], v[240:241], v[40:41], v[64:65] op_sel_hi:[1,0,1] neg_lo:[0,1,0] neg_hi:[0,1,0]
  v_pk_fma_f32 v[66:67], v[242:243], v[40:41], v[66:67] op_sel_hi:[1,0,1] neg_lo:[0,1,0] neg_hi:[0,1,0]
  v_pk_fma_f32 v[68:69], v[244:245], v[40:41], v[68:69] op_sel_hi:[1,0,1] neg_lo:[0,1,0] neg_hi:[0,1,0]
  v_pk_fma_f32 v[70:71], v[246:247], v[40:41], v[70:71] op_sel_hi:[1,0,1] neg_lo:[0,1,0] neg_hi:[0,1,0]
  v_pk_fma_f32 v[72:73], v[248:249], v[40:41], v[72:73] op_sel_hi:[1,0,1] neg_lo:[0,1,0] neg_hi:[0,1,0]
  v_pk_fma_f32 v[74:75], v[250:251], v[40:41], v[74:75] op_sel_hi:[1,0,1] neg_lo:[0,1,0] neg_hi:[0,1,0]
  v_pk_fma_f32 v[76:77], v[252:253], v[40:41], v[76:77] op_sel_hi:[1,0,1] neg_lo:[0,1,0] neg_hi:[0,1,0]
  v_pk_fma_f32 v[78:79], v[254:255], v[40:41], v[78:79] op_sel_hi:[1,0,1] neg_lo:[0,1,0] neg_hi:[0,1,0]
  v_pk_mul_f32 v[64:65], v[64:65], v[42:43] op_sel_hi:[1,0]
  v_pk_mul_f32 v[66:67], v[66:67], v[42:43] op_sel_hi:[1,0]
  v_pk_mul_f32 v[68:69], v[68:69], v[42:43] op_sel_hi:[1,0]
  v_pk_mul_f32 v[70:71], v[70:71], v[42:43] op_sel_hi:[1,0]
  v_pk_mul_f32 v[72:73], v[72:73], v[42:43] op_sel_hi:[1,0]
  v_pk_mul_f32 v[74:75], v[74:75], v[42:43] op_sel_hi:[1,0]
  v_pk_mul_f32 v[76:77], v[76:77], v[42:43] op_sel_hi:[1,0]
  v_pk_mul_f32 v[78:79], v[78:79], v[42:43] op_sel_hi:[1,0]
  v_cvt_pk_bf16_f32 v64, v64, v65
  v_cvt_pk_bf16_f32 v65, v66, v67
  v_cvt_pk_bf16_f32 v66, v68, v69
  v_cvt_pk_bf16_f32 v67, v70, v71
  v_cvt_pk_bf16_f32 v68, v72, v73
  v_cvt_pk_bf16_f32 v69, v74, v75
  v_cvt_pk_bf16_f32 v70, v76, v77
  v_cvt_pk_bf16_f32 v71, v78, v79
  v_cndmask_b32_e64 v70, v70, v44, s[34:35]
  v_cndmask_b32_e64 v71, v71, 0, s[34:35]
  buffer_store_dwordx4 v[64:67], v4, s[20:23], s49 offen
  buffer_store_dwordx4 v[68:71], v4, s[20:23], s49 offen offset:1024
  s_branch L_m_pq
L_m_pv:
  s_waitcnt lgkmcnt(5)
  v_mfma_f32_32x32x16_bf16 v[80:95], v[112:115], v[112:115], 0
  ds_read_b128 v[120:123], v18 offset:0
  ds_read_b64_tr_b16 v[240:241], v26 offset:0
  v_mfma_f32_16x16x32_bf16 v[96:99], v[36:39], v[112:115], 0
  ds_read_b64_tr_b16 v[242:243], v26 offset:512
  v_mfma_f32_32x32x16_bf16 v[48:63], v[112:115], v[224:227], 0
  ds_read_b64_tr_b16 v[244:245], v30 offset:0
  ds_read_b64_tr_b16 v[246:247], v30 offset:512
  v_mfma_f32_32x32x16_bf16 v[64:79], v[112:115], v[228:231], 0
  s_waitcnt lgkmcnt(5)
  v_mfma_f32_32x32x16_bf16 v[80:95], v[116:119], v[116:119], v[80:95]
  ds_read_b128 v[124:127], v19 offset:0
  ds_read_b64_tr_b16 v[248:249], v27 offset:0
  v_mfma_f32_16x16x32_bf16 v[96:99], v[36:39], v[116:119], v[96:99]
  ds_read_b64_tr_b16 v[250:251], v27 offset:512
  v_mfma_f32_32x32x16_bf16 v[48:63], v[116:119], v[232:235], v[48:63]
  ds_read_b64_tr_b16 v[252:253], v31 offset:0
  ds_read_b64_tr_b16 v[254:255], v31 offset:512
  v_mfma_f32_32x32x16_bf16 v[64:79], v[116:119], v[236:239], v[64:79]
  s_barrier
  s_waitcnt lgkmcnt(5)
  v_mfma_f32_32x32x16_bf16 v[80:95], v[120:123], v[120:123], v[80:95]
  ds_read_b128 v[128:131], v16 offset:16384
  ds_read_b64_tr_b16 v[224:225], v24 offset:8192
  v_mfma_f32_16x16x32_bf16 v[96:99], v[36:39], v[120:123], v[96:99]
  ds_read_b64_tr_b16 v[226:227], v24 offset:8704
  v_mfma_f32_32x32x16_bf16 v[48:63], v[120:123], v[240:243], v[48:63]
  ds_read_b64_tr_b16 v[228:229], v28 offset:8192
  ds_read_b64_tr_b16 v[230:231], v28 offset:8704
  v_mfma_f32_32x32x16_bf16 v[64:79], v[120:123], v[244:247], v[64:79]
  s_waitcnt lgkmcnt(5)
  v_mfma_f32_32x32x16_bf16 v[80:95], v[124:127], v[124:127], v[80:95]
  ds_read_b128 v[132:135], v17 offset:16384
  ds_read_b64_tr_b16 v[232:233], v25 offset:8192
  v_mfma_f32_16x16x32_bf16 v[96:99], v[36:39], v[124:127], v[96:99]
  ds_read_b64_tr_b16 v[234:235], v25 offset:8704
  v_mfma_f32_32x32x16_bf16 v[48:63], v[124:127], v[248:251], v[48:63]
  ds_read_b64_tr_b16 v[236:237], v29 offset:8192
  ds_read_b64_tr_b16 v[238:239], v29 offset:8704
  v_mfma_f32_32x32x16_bf16 v[64:79], v[124:127], v[252:255], v[64:79]
  s_waitcnt lgkmcnt(5)
  v_mfma_f32_32x32x16_bf16 v[80:95], v[128:131], v[128:131], v[80:95]
  ds_read_b128 v[136:139], v18 offset:16384
  ds_read_b64_tr_b16 v[240:241], v26 offset:8192
  v_mfma_f32_16x16x32_bf16 v[96:99], v[36:39], v[128:131], v[96:99]
  ds_read_b64_tr_b16 v[242:243], v26 offset:8704
  v_mfma_f32_32x32x16_bf16 v[48:63], v[128:131], v[224:227], v[48:63]
  ds_read_b64_tr_b16 v[244:245], v30 offset:8192
  ds_read_b64_tr_b16 v[246:247], v30 offset:8704
  v_mfma_f32_32x32x16_bf16 v[64:79], v[128:131], v[228:231], v[64:79]
  s_waitcnt lgkmcnt(5)
  v_mfma_f32_32x32x16_bf16 v[80:95], v[132:135], v[132:135], v[80:95]
  ds_read_b128 v[140:143], v19 offset:16384
  ds_read_b64_tr_b16 v[248:249], v27 offset:8192
  v_mfma_f32_16x16x32_bf16 v[96:99], v[36:39], v[132:135], v[96:99]
  ds_read_b64_tr_b16 v[250:251], v27 offset:8704
  v_mfma_f32_32x32x16_bf16 v[48:63], v[132:135], v[232:235], v[48:63]
  ds_read_b64_tr_b16 v[252:253], v31 offset:8192
  ds_read_b64_tr_b16 v[254:255], v31 offset:8704
  v_mfma_f32_32x32x16_bf16 v[64:79], v[132:135], v[236:239], v[64:79]
  s_barrier
  s_waitcnt lgkmcnt(5)
  v_mfma_f32_32x32x16_bf16 v[80:95], v[136:139], v[136:139], v[80:95]
  ds_read_b128 v[144:147], v16 offset:32768
  ds_read_b64_tr_b16 v[224:225], v24 offset:16384
  v_mfma_f32_16x16x32_bf16 v[96:99], v[36:39], v[136:139], v[96:99]
  ds_read_b64_tr_b16 v[226:227], v24 offset:16896
  v_mfma_f32_32x32x16_bf16 v[48:63], v[136:139], v[240:243], v[48:63]
  ds_read_b64_tr_b16 v[228:229], v28 offset:16384
  ds_read_b64_tr_b16 v[230:231], v28 offset:16896
  v_mfma_f32_32x32x16_bf16 v[64:79], v[136:139], v[244:247], v[64:79]
  s_waitcnt lgkmcnt(5)
  v_mfma_f32_32x32x16_bf16 v[80:95], v[140:143], v[140:143], v[80:95]
  ds_read_b128 v[148:151], v17 offset:32768
  ds_read_b64_tr_b16 v[232:233], v25 offset:16384
  v_mfma_f32_16x16x32_bf16 v[96:99], v[36:39], v[140:143], v[96:99]
  ds_read_b64_tr_b16 v[234:235], v25 offset:16896
  v_mfma_f32_32x32x16_bf16 v[48:63], v[140:143], v[248:251], v[48:63]
  ds_read_b64_tr_b16 v[236:237], v29 offset:16384
  ds_read_b64_tr_b16 v[238:239], v29 offset:16896
  v_mfma_f32_32x32x16_bf16 v[64:79], v[140:143], v[252:255], v[64:79]
  s_waitcnt lgkmcnt(5)
  v_mfma_f32_32x32x16_bf16 v[80:95], v[144:147], v[144:147], v[80:95]
  ds_read_b128 v[152:155], v18 offset:32768
  ds_read_b64_tr_b16 v[240:241], v26 offset:16384
  v_mfma_f32_16x16x32_bf16 v[96:99], v[36:39], v[144:147], v[96:99]
  ds_read_b64_tr_b16 v[242:243], v26 offset:16896
  v_mfma_f32_32x32x16_bf16 v[48:63], v[144:147], v[224:227], v[48:63]
  ds_read_b64_tr_b16 v[244:245], v30 offset:16384
  ds_read_b64_tr_b16 v[246:247], v30 offset:16896
  v_mfma_f32_32x32x16_bf16 v[64:79], v[144:147], v[228:231], v[64:79]
  s_waitcnt lgkmcnt(5)
  v_mfma_f32_32x32x16_bf16 v[80:95], v[148:151], v[148:151], v[80:95]
  ds_read_b128 v[156:159], v19 offset:32768
  ds_read_b64_tr_b16 v[248:249], v27 offset:16384
  v_mfma_f32_16x16x32_bf16 v[96:99], v[36:39], v[148:151], v[96:99]
  ds_read_b64_tr_b16 v[250:251], v27 offset:16896
  v_mfma_f32_32x32x16_bf16 v[48:63], v[148:151], v[232:235], v[48:63]
  ds_read_b64_tr_b16 v[252:253], v31 offset:16384
  ds_read_b64_tr_b16 v[254:255], v31 offset:16896
  v_mfma_f32_32x32x16_bf16 v[64:79], v[148:151], v[236:239], v[64:79]
  s_barrier
  s_waitcnt lgkmcnt(5)
  v_mfma_f32_32x32x16_bf16 v[80:95], v[152:155], v[152:155], v[80:95]
  ds_read_b128 v[160:163], v16 offset:49152
  ds_read_b64_tr_b16 v[224:225], v24 offset:24576
  v_mfma_f32_16x16x32_bf16 v[96:99], v[36:39], v[152:155], v[96:99]
  ds_read_b64_tr_b16 v[226:227], v24 offset:25088
  v_mfma_f32_32x32x16_bf16 v[48:63], v[152:155], v[240:243], v[48:63]
  ds_read_b64_tr_b16 v[228:229], v28 offset:24576
  ds_read_b64_tr_b16 v[230:231], v28 offset:25088
  v_mfma_f32_32x32x16_bf16 v[64:79], v[152:155], v[244:247], v[64:79]
  s_waitcnt lgkmcnt(5)
  v_mfma_f32_32x32x16_bf16 v[80:95], v[156:159], v[156:159], v[80:95]
  ds_read_b128 v[164:167], v17 offset:49152
  ds_read_b64_tr_b16 v[232:233], v25 offset:24576
  v_mfma_f32_16x16x32_bf16 v[96:99], v[36:39], v[156:159], v[96:99]
  ds_read_b64_tr_b16 v[234:235], v25 offset:25088
  v_mfma_f32_32x32x16_bf16 v[48:63], v[156:159], v[248:251], v[48:63]
  ds_read_b64_tr_b16 v[236:237], v29 offset:24576
  ds_read_b64_tr_b16 v[238:239], v29 offset:25088
  v_mfma_f32_32x32x16_bf16 v[64:79], v[156:159], v[252:255], v[64:79]
  s_waitcnt lgkmcnt(5)
  v_mfma_f32_32x32x16_bf16 v[80:95], v[160:163], v[160:163], v[80:95]
  ds_read_b128 v[168:171], v18 offset:49152
  ds_read_b64_tr_b16 v[240:241], v26 offset:24576
  v_mfma_f32_16x16x32_bf16 v[96:99], v[36:39], v[160:163], v[96:99]
  ds_read_b64_tr_b16 v[242:243], v26 offset:25088
  v_mfma_f32_32x32x16_bf16 v[48:63], v[160:163], v[224:227], v[48:63]
  ds_read_b64_tr_b16 v[244:245], v30 offset:24576
  ds_read_b64_tr_b16 v[246:247], v30 offset:25088
  v_mfma_f32_32x32x16_bf16 v[64:79], v[160:163], v[228:231], v[64:79]
  s_waitcnt lgkmcnt(5)
  v_mfma_f32_32x32x16_bf16 v[80:95], v[164:167], v[164:167], v[80:95]
  ds_read_b128 v[172:175], v19 offset:49152
  ds_read_b64_tr_b16 v[248:249], v27 offset:24576
  v_mfma_f32_16x16x32_bf16 v[96:99], v[36:39], v[164:167], v[96:99]
  ds_read_b64_tr_b16 v[250:251], v27 offset:25088
  v_mfma_f32_32x32x16_bf16 v[48:63], v[164:167], v[232:235], v[48:63]
  ds_read_b64_tr_b16 v[252:253], v31 offset:24576
  ds_read_b64_tr_b16 v[254:255], v31 offset:25088
  v_mfma_f32_32x32x16_bf16 v[64:79], v[164:167], v[236:239], v[64:79]
  s_barrier
  s_waitcnt lgkmcnt(5)
  v_mfma_f32_32x32x16_bf16 v[80:95], v[168:171], v[168:171], v[80:95]
  ds_read_b128 v[176:179], v20 offset:0
  ds_read_b64_tr_b16 v[224:225], v24 offset:32768
  v_mfma_f32_16x16x32_bf16 v[96:99], v[36:39], v[168:171], v[96:99]
  ds_read_b64_tr_b16 v[226:227], v24 offset:33280
  v_mfma_f32_32x32x16_bf16 v[48:63], v[168:171], v[240:243], v[48:63]
  ds_read_b64_tr_b16 v[228:229], v28 offset:32768
  ds_read_b64_tr_b16 v[230:231], v28 offset:33280
  v_mfma_f32_32x32x16_bf16 v[64:79], v[168:171], v[244:247], v[64:79]
  s_waitcnt lgkmcnt(5)
  v_mfma_f32_32x32x16_bf16 v[80:95], v[172:175], v[172:175], v[80:95]
  ds_read_b128 v[180:183], v21 offset:0
  ds_read_b64_tr_b16 v[232:233], v25 offset:32768
  v_mfma_f32_16x16x32_bf16 v[96:99], v[36:39], v[172:175], v[96:99]
  ds_read_b64_tr_b16 v[234:235], v25 offset:33280
  v_mfma_f32_32x32x16_bf16 v[48:63], v[172:175], v[248:251], v[48:63]
  ds_read_b64_tr_b16 v[236:237], v29 offset:32768
  ds_read_b64_tr_b16 v[238:239], v29 offset:33280
  v_mfma_f32_32x32x16_bf16 v[64:79], v[172:175], v[252:255], v[64:79]
  s_waitcnt lgkmcnt(5)
  v_mfma_f32_32x32x16_bf16 v[80:95], v[176:179], v[176:179], v[80:95]
  ds_read_b128 v[184:187], v22 offset:0
  ds_read_b64_tr_b16 v[240:241], v26 offset:32768
  v_mfma_f32_16x16x32_bf16 v[96:99], v[36:39], v[176:179], v[96:99]
  ds_read_b64_tr_b16 v[242:243], v26 offset:33280
  v_mfma_f32_32x32x16_bf16 v[48:63], v[176:179], v[224:227], v[48:63]
  ds_read_b64_tr_b16 v[244:245], v30 offset:32768
  ds_read_b64_tr_b16 v[246:247], v30 offset:33280
  v_mfma_f32_32x32x16_bf16 v[64:79], v[176:179], v[228:231], v[64:79]
  s_waitcnt lgkmcnt(5)
  v_mfma_f32_32x32x16_bf16 v[80:95], v[180:183], v[180:183], v[80:95]
  ds_read_b128 v[188:191], v23 offset:0
  ds_read_b64_tr_b16 v[248:249], v27 offset:32768
  v_mfma_f32_16x16x32_bf16 v[96:99], v[36:39], v[180:183], v[96:99]
  ds_read_b64_tr_b16 v[250:251], v27 offset:33280
  v_mfma_f32_32x32x16_bf16 v[48:63], v[180:183], v[232:235], v[48:63]
  ds_read_b64_tr_b16 v[252:253], v31 offset:32768
  ds_read_b64_tr_b16 v[254:255], v31 offset:33280
  v_mfma_f32_32x32x16_bf16 v[64:79], v[180:183], v[236:239], v[64:79]
  s_barrier
  buffer_load_dword v46, v46, s[20:23], s48 offen
  s_waitcnt lgkmcnt(5)
  v_mfma_f32_32x32x16_bf16 v[80:95], v[184:187], v[184:187], v[80:95]
  ds_read_b128 v[192:195], v20 offset:16384
  ds_read_b64_tr_b16 v[224:225], v24 offset:40960
  v_mfma_f32_16x16x32_bf16 v[96:99], v[36:39], v[184:187], v[96:99]
  ds_read_b64_tr_b16 v[226:227], v24 offset:41472
  v_mfma_f32_32x32x16_bf16 v[48:63], v[184:187], v[240:243], v[48:63]
  ds_read_b64_tr_b16 v[228:229], v28 offset:40960
  ds_read_b64_tr_b16 v[230:231], v28 offset:41472
  v_mfma_f32_32x32x16_bf16 v[64:79], v[184:187], v[244:247], v[64:79]
  s_waitcnt lgkmcnt(5)
  v_mfma_f32_32x32x16_bf16 v[80:95], v[188:191], v[188:191], v[80:95]
  ds_read_b128 v[196:199], v21 offset:16384
  ds_read_b64_tr_b16 v[232:233], v25 offset:40960
  v_mfma_f32_16x16x32_bf16 v[96:99], v[36:39], v[188:191], v[96:99]
  ds_read_b64_tr_b16 v[234:235], v25 offset:41472
  v_mfma_f32_32x32x16_bf16 v[48:63], v[188:191], v[248:251], v[48:63]
  ds_read_b64_tr_b16 v[236:237], v29 offset:40960
  ds_read_b64_tr_b16 v[238:239], v29 offset:41472
  v_mfma_f32_32x32x16_bf16 v[64:79], v[188:191], v[252:255], v[64:79]
  s_waitcnt lgkmcnt(5)
  v_mfma_f32_32x32x16_bf16 v[80:95], v[192:195], v[192:195], v[80:95]
  ds_read_b128 v[200:203], v22 offset:16384
  ds_read_b64_tr_b16 v[240:241], v26 offset:40960
  v_mfma_f32_16x16x32_bf16 v[96:99], v[36:39], v[192:195], v[96:99]
  ds_read_b64_tr_b16 v[242:243], v26 offset:41472
  v_mfma_f32_32x32x16_bf16 v[48:63], v[192:195], v[224:227], v[48:63]
  ds_read_b64_tr_b16 v[244:245], v30 offset:40960
  ds_read_b64_tr_b16 v[246:247], v30 offset:41472
  v_mfma_f32_32x32x16_bf16 v[64:79], v[192:195], v[228:231], v[64:79]
  s_waitcnt lgkmcnt(5)
  v_mfma_f32_32x32x16_bf16 v[80:95], v[196:199], v[196:199], v[80:95]
  ds_read_b128 v[204:207], v23 offset:16384
  ds_read_b64_tr_b16 v[248:249], v27 offset:40960
  v_mfma_f32_16x16x32_bf16 v[96:99], v[36:39], v[196:199], v[96:99]
  ds_read_b64_tr_b16 v[250:251], v27 offset:41472
  v_mfma_f32_32x32x16_bf16 v[48:63], v[196:199], v[232:235], v[48:63]
  ds_read_b64_tr_b16 v[252:253], v31 offset:40960
  ds_read_b64_tr_b16 v[254:255], v31 offset:41472
  v_mfma_f32_32x32x16_bf16 v[64:79], v[196:199], v[236:239], v[64:79]
  s_barrier
  s_waitcnt lgkmcnt(5)
  v_mfma_f32_32x32x16_bf16 v[80:95], v[200:203], v[200:203], v[80:95]
  ds_read_b128 v[208:211], v16 offset:0
  ds_read_b64_tr_b16 v[224:225], v24 offset:0
  v_mfma_f32_16x16x32_bf16 v[96:99], v[36:39], v[200:203], v[96:99]
  ds_read_b64_tr_b16 v[226:227], v24 offset:512
  v_mfma_f32_32x32x16_bf16 v[48:63], v[200:203], v[240:243], v[48:63]
  ds_read_b64_tr_b16 v[228:229], v28 offset:0
  ds_read_b64_tr_b16 v[230:231], v28 offset:512
  v_mfma_f32_32x32x16_bf16 v[64:79], v[200:203], v[244:247], v[64:79]
  s_waitcnt lgkmcnt(5)
  v_mfma_f32_32x32x16_bf16 v[80:95], v[204:207], v[204:207], v[80:95]
  ds_read_b128 v[212:215], v17 offset:0
  ds_read_b64_tr_b16 v[232:233], v25 offset:0
  v_mfma_f32_16x16x32_bf16 v[96:99], v[36:39], v[204:207], v[96:99]
  ds_read_b64_tr_b16 v[234:235], v25 offset:512
  v_mfma_f32_32x32x16_bf16 v[48:63], v[204:207], v[248:251], v[48:63]
  ds_read_b64_tr_b16 v[236:237], v29 offset:0
  ds_read_b64_tr_b16 v[238:239], v29 offset:512
  v_mfma_f32_32x32x16_bf16 v[64:79], v[204:207], v[252:255], v[64:79]
  s_waitcnt lgkmcnt(5)
  v_mfma_f32_32x32x16_bf16 v[80:95], v[208:211], v[208:211], v[80:95]
  ds_read_b128 v[216:219], v18 offset:0
  ds_read_b64_tr_b16 v[240:241], v26 offset:0
  v_mfma_f32_16x16x32_bf16 v[96:99], v[36:39], v[208:211], v[96:99]
  ds_read_b64_tr_b16 v[242:243], v26 offset:512
  v_mfma_f32_32x32x16_bf16 v[48:63], v[208:211], v[224:227], v[48:63]
  ds_read_b64_tr_b16 v[244:245], v30 offset:0
  ds_read_b64_tr_b16 v[246:247], v30 offset:512
  v_mfma_f32_32x32x16_bf16 v[64:79], v[208:211], v[228:231], v[64:79]
  s_waitcnt lgkmcnt(5)
  v_mfma_f32_32x32x16_bf16 v[80:95], v[212:215], v[212:215], v[80:95]
  ds_read_b128 v[220:223], v19 offset:0
  ds_read_b64_tr_b16 v[248:249], v27 offset:0
  v_mfma_f32_16x16x32_bf16 v[96:99], v[36:39], v[212:215], v[96:99]
  ds_read_b64_tr_b16 v[250:251], v27 offset:512
  v_mfma_f32_32x32x16_bf16 v[48:63], v[212:215], v[232:235], v[48:63]
  ds_read_b64_tr_b16 v[252:253], v31 offset:0
  ds_read_b64_tr_b16 v[254:255], v31 offset:512
  v_mfma_f32_32x32x16_bf16 v[64:79], v[212:215], v[236:239], v[64:79]
  s_waitcnt lgkmcnt(5)
  v_mfma_f32_32x32x16_bf16 v[80:95], v[216:219], v[216:219], v[80:95]
  v_mfma_f32_16x16x32_bf16 v[96:99], v[36:39], v[216:219], v[96:99]
  v_mfma_f32_32x32x16_bf16 v[48:63], v[216:219], v[240:243], v[48:63]
  v_mfma_f32_32x32x16_bf16 v[64:79], v[216:219], v[244:247], v[64:79]
  s_waitcnt lgkmcnt(0)
  v_mfma_f32_32x32x16_bf16 v[80:95], v[220:223], v[220:223], v[80:95]
  v_mfma_f32_16x16x32_bf16 v[96:99], v[36:39], v[220:223], v[96:99]
  v_mfma_f32_32x32x16_bf16 v[48:63], v[220:223], v[248:251], v[48:63]
  v_mfma_f32_32x32x16_bf16 v[64:79], v[220:223], v[252:255], v[64:79]
  s_mov_b32 s52, 0x3b124925
  s_mov_b32 s44, 0xaaaaaaaa
  s_mov_b32 s45, 0xaaaaaaaa
  s_mov_b32 s46, 0xcccccccc
  s_mov_b32 s47, 0xcccccccc
  s_mov_b32 s38, 0xff00ff00
  s_mov_b32 s39, 0xff00ff00
  s_mov_b32 vcc_lo, 0xffff0000
  s_mov_b32 vcc_hi, 0xffff0000
  s_mov_b32 s52, 0x3b124925
  v_cndmask_b32_e64 v80, v80, v81, s[44:45]
  v_cndmask_b32_e64 v82, v82, v83, s[44:45]
  v_cndmask_b32_e64 v84, v84, v85, s[44:45]
  v_cndmask_b32_e64 v86, v86, v87, s[44:45]
  v_cndmask_b32_e64 v88, v88, v89, s[44:45]
  v_cndmask_b32_e64 v90, v90, v91, s[44:45]
  v_cndmask_b32_e64 v92, v92, v93, s[44:45]
  v_cndmask_b32_e64 v94, v94, v95, s[44:45]
  v_cndmask_b32_e64 v80, v80, v82, s[46:47]
  v_cndmask_b32_e64 v84, v84, v86, s[46:47]
  v_cndmask_b32_e64 v88, v88, v90, s[46:47]
  v_cndmask_b32_e64 v92, v92, v94, s[46:47]
  v_cndmask_b32_e64 v80, v80, v84, s[38:39]
  v_cndmask_b32_e64 v88, v88, v92, s[38:39]
  v_cndmask_b32 v80, v80, v88, vcc
  v_cndmask_b32 v40, v96, v97, vcc
  v_mov_b32 v81, v80
  s_mov_b32 s44, 0xf0f0f0f0
  s_mov_b32 s45, 0xf0f0f0f0
  v_permlane32_swap_b32 v80, v81
  v_mul_f32 v40, s52, v40
  s_barrier
  ds_read_b32 v104, v101 offset:0
  ds_read_b32 v106, v101 offset:128
  ds_read_b32 v10, v10
  v_cndmask_b32_e64 v42, v80, v81, s[44:45]
  v_mul_f32 v42, s52, v42
  v_fma_f32 v42, -v40, v40, v42
  v_max_f32 v42, 0, v42
  v_cvt_pk_bf16_f32 v82, v40, v40
  v_lshlrev_b32 v40, 16, v82
  ds_write_b32 v102, v40
  ds_read_b128 v[224:227], v103 offset:0
  ds_read_b128 v[228:231], v103 offset:32
  ds_read_b128 v[232:235], v103 offset:64
  ds_read_b128 v[236:239], v103 offset:96
  v_cvt_pk_bf16_f32 v82, v42, v42
  v_lshlrev_b32 v42, 16, v82
  v_add_f32 v42, 0x3727c5ac, v42
  v_cvt_pk_bf16_f32 v82, v42, v42
  v_lshlrev_b32 v42, 16, v82
  v_sqrt_f32 v42, v42
  s_nop 0
  v_cvt_pk_bf16_f32 v82, v42, v42
  v_lshlrev_b32 v42, 16, v82
  v_rcp_f32 v42, v42
  s_nop 0
  ds_write_b32 v102, v42 offset:512
  ds_read_b128 v[240:243], v103 offset:512
  ds_read_b128 v[244:247], v103 offset:544
  ds_read_b128 v[248:251], v103 offset:576
  ds_read_b128 v[252:255], v103 offset:608
  s_waitcnt lgkmcnt(5)
  v_pk_fma_f32 v[48:49], v[224:225], v[104:105], v[48:49] op_sel_hi:[1,0,1] neg_lo:[0,1,0] neg_hi:[0,1,0]
  v_pk_fma_f32 v[50:51], v[226:227], v[104:105], v[50:51] op_sel_hi:[1,0,1] neg_lo:[0,1,0] neg_hi:[0,1,0]
  v_pk_fma_f32 v[52:53], v[228:229], v[104:105], v[52:53] op_sel_hi:[1,0,1] neg_lo:[0,1,0] neg_hi:[0,1,0]
  v_pk_fma_f32 v[54:55], v[230:231], v[104:105], v[54:55] op_sel_hi:[1,0,1] neg_lo:[0,1,0] neg_hi:[0,1,0]
  v_pk_fma_f32 v[56:57], v[232:233], v[104:105], v[56:57] op_sel_hi:[1,0,1] neg_lo:[0,1,0] neg_hi:[0,1,0]
  v_pk_fma_f32 v[58:59], v[234:235], v[104:105], v[58:59] op_sel_hi:[1,0,1] neg_lo:[0,1,0] neg_hi:[0,1,0]
  v_pk_fma_f32 v[60:61], v[236:237], v[104:105], v[60:61] op_sel_hi:[1,0,1] neg_lo:[0,1,0] neg_hi:[0,1,0]
  v_pk_fma_f32 v[62:63], v[238:239], v[104:105], v[62:63] op_sel_hi:[1,0,1] neg_lo:[0,1,0] neg_hi:[0,1,0]
  v_pk_fma_f32 v[64:65], v[224:225], v[106:107], v[64:65] op_sel_hi:[1,0,1] neg_lo:[0,1,0] neg_hi:[0,1,0]
  v_pk_fma_f32 v[66:67], v[226:227], v[106:107], v[66:67] op_sel_hi:[1,0,1] neg_lo:[0,1,0] neg_hi:[0,1,0]
  v_pk_fma_f32 v[68:69], v[228:229], v[106:107], v[68:69] op_sel_hi:[1,0,1] neg_lo:[0,1,0] neg_hi:[0,1,0]
  v_pk_fma_f32 v[70:71], v[230:231], v[106:107], v[70:71] op_sel_hi:[1,0,1] neg_lo:[0,1,0] neg_hi:[0,1,0]
  v_pk_fma_f32 v[72:73], v[232:233], v[106:107], v[72:73] op_sel_hi:[1,0,1] neg_lo:[0,1,0] neg_hi:[0,1,0]
  v_pk_fma_f32 v[74:75], v[234:235], v[106:107], v[74:75] op_sel_hi:[1,0,1] neg_lo:[0,1,0] neg_hi:[0,1,0]
  v_pk_fma_f32 v[76:77], v[236:237], v[106:107], v[76:77] op_sel_hi:[1,0,1] neg_lo:[0,1,0] neg_hi:[0,1,0]
  v_pk_fma_f32 v[78:79], v[238:239], v[106:107], v[78:79] op_sel_hi:[1,0,1] neg_lo:[0,1,0] neg_hi:[0,1,0]
  s_waitcnt lgkmcnt(0)
  v_pk_mul_f32 v[48:49], v[48:49], v[240:241]
  v_pk_mul_f32 v[50:51], v[50:51], v[242:243]
  v_pk_mul_f32 v[52:53], v[52:53], v[244:245]
  v_pk_mul_f32 v[54:55], v[54:55], v[246:247]
  v_pk_mul_f32 v[56:57], v[56:57], v[248:249]
  v_pk_mul_f32 v[58:59], v[58:59], v[250:251]
  v_pk_mul_f32 v[60:61], v[60:61], v[252:253]
  v_pk_mul_f32 v[62:63], v[62:63], v[254:255]
  v_cvt_pk_bf16_f32 v48, v48, v49
  v_cvt_pk_bf16_f32 v49, v50, v51
  v_cvt_pk_bf16_f32 v50, v52, v53
  v_cvt_pk_bf16_f32 v51, v54, v55
  v_cvt_pk_bf16_f32 v52, v56, v57
  v_cvt_pk_bf16_f32 v53, v58, v59
  v_cvt_pk_bf16_f32 v54, v60, v61
  v_cvt_pk_bf16_f32 v55, v62, v63
  v_cndmask_b32_e64 v48, v48, v45, s[62:63]
  v_cndmask_b32_e64 v49, v49, v45, s[62:63]
  v_cndmask_b32_e64 v50, v50, v45, s[62:63]
  v_cndmask_b32_e64 v51, v51, v45, s[62:63]
  v_cndmask_b32_e64 v52, v52, v45, s[62:63]
  v_cndmask_b32_e64 v53, v53, v45, s[62:63]
  v_cndmask_b32_e64 v54, v54, v45, s[62:63]
  v_cndmask_b32_e64 v55, v55, v45, s[62:63]
  buffer_store_dwordx4 v[48:51], v4, s[20:23], s48 offen
  buffer_store_dwordx4 v[52:55], v4, s[20:23], s48 offen offset:1024
  v_pk_mul_f32 v[64:65], v[64:65], v[240:241]
  v_pk_mul_f32 v[66:67], v[66:67], v[242:243]
  v_pk_mul_f32 v[68:69], v[68:69], v[244:245]
  v_pk_mul_f32 v[70:71], v[70:71], v[246:247]
  v_pk_mul_f32 v[72:73], v[72:73], v[248:249]
  v_pk_mul_f32 v[74:75], v[74:75], v[250:251]
  v_pk_mul_f32 v[76:77], v[76:77], v[252:253]
  v_pk_mul_f32 v[78:79], v[78:79], v[254:255]
  v_cvt_pk_bf16_f32 v64, v64, v65
  v_cvt_pk_bf16_f32 v65, v66, v67
  v_cvt_pk_bf16_f32 v66, v68, v69
  v_cvt_pk_bf16_f32 v67, v70, v71
  v_cvt_pk_bf16_f32 v68, v72, v73
  v_cvt_pk_bf16_f32 v69, v74, v75
  v_cvt_pk_bf16_f32 v70, v76, v77
  v_cvt_pk_bf16_f32 v71, v78, v79
  v_cndmask_b32_e64 v64, v64, v45, s[62:63]
  v_cndmask_b32_e64 v65, v65, v45, s[62:63]
  v_cndmask_b32_e64 v66, v66, v45, s[62:63]
  v_cndmask_b32_e64 v67, v67, v45, s[62:63]
  v_cndmask_b32_e64 v68, v68, v45, s[62:63]
  v_cndmask_b32_e64 v69, v69, v45, s[62:63]
  v_cndmask_b32_e64 v70, v70, v45, s[62:63]
  v_cndmask_b32_e64 v71, v71, v45, s[62:63]
  buffer_store_dwordx4 v[64:67], v4, s[20:23], s49 offen
  buffer_store_dwordx4 v[68:71], v4, s[20:23], s49 offen offset:1024
L_m_pq:
  s_waitcnt lgkmcnt(0)
  v_readfirstlane_b32 s99, v10
  v_mul_f32 v42, 0x3e8b97f6, v42
  s_barrier
  ds_read_b128 v[240:243], v100 offset:256
  ds_read_b128 v[244:247], v100 offset:288
  ds_read_b128 v[248:251], v100 offset:320
  ds_read_b128 v[252:255], v100 offset:352
  ds_read_b64_tr_b16 v[224:225], v32 offset:0
  ds_read_b64_tr_b16 v[226:227], v32 offset:256
  ds_read_b64_tr_b16 v[228:229], v33 offset:0
  ds_read_b64_tr_b16 v[230:231], v33 offset:256
  ds_read_b64_tr_b16 v[232:233], v34 offset:0
  ds_read_b64_tr_b16 v[234:235], v34 offset:256
  s_waitcnt lgkmcnt(4)
  v_mfma_f32_32x32x16_bf16 v[80:95], v[224:227], v[112:115], 0
  ds_read_b64_tr_b16 v[236:237], v35 offset:0
  ds_read_b64_tr_b16 v[238:239], v35 offset:256
  s_waitcnt lgkmcnt(4)
  v_mfma_f32_32x32x16_bf16 v[80:95], v[228:231], v[116:119], v[80:95]
  ds_read_b64_tr_b16 v[224:225], v32 offset:4096
  ds_read_b64_tr_b16 v[226:227], v32 offset:4352
  s_waitcnt lgkmcnt(4)
  v_mfma_f32_32x32x16_bf16 v[80:95], v[232:235], v[120:123], v[80:95]
  ds_read_b64_tr_b16 v[228:229], v33 offset:4096
  ds_read_b64_tr_b16 v[230:231], v33 offset:4352
  s_waitcnt lgkmcnt(4)
  v_mfma_f32_32x32x16_bf16 v[80:95], v[236:239], v[124:127], v[80:95]
  ds_read_b64_tr_b16 v[232:233], v34 offset:4096
  ds_read_b64_tr_b16 v[234:235], v34 offset:4352
  s_waitcnt lgkmcnt(4)
  v_mfma_f32_32x32x16_bf16 v[80:95], v[224:227], v[128:131], v[80:95]
  ds_read_b64_tr_b16 v[236:237], v35 offset:4096
  ds_read_b64_tr_b16 v[238:239], v35 offset:4352
  s_waitcnt vmcnt(0)
  v_mov_b32 v10, 1
  s_cmp_lg_u32 s99, 0
  s_cbranch_scc1 L_ps_1
  buffer_store_dword v10, v47, s[20:23], s50 offen
L_pb_2:
  s_waitcnt lgkmcnt(4)
  v_mfma_f32_32x32x16_bf16 v[80:95], v[228:231], v[132:135], v[80:95]
  ds_read_b64_tr_b16 v[224:225], v32 offset:8192
  ds_read_b64_tr_b16 v[226:227], v32 offset:8448
  s_waitcnt lgkmcnt(4)
  v_mfma_f32_32x32x16_bf16 v[80:95], v[232:235], v[136:139], v[80:95]
  ds_read_b64_tr_b16 v[228:229], v33 offset:8192
  ds_read_b64_tr_b16 v[230:231], v33 offset:8448
  s_waitcnt lgkmcnt(4)
  v_mfma_f32_32x32x16_bf16 v[80:95], v[236:239], v[140:143], v[80:95]
  ds_read_b64_tr_b16 v[232:233], v34 offset:8192
  ds_read_b64_tr_b16 v[234:235], v34 offset:8448
  s_waitcnt lgkmcnt(4)
  v_mfma_f32_32x32x16_bf16 v[80:95], v[224:227], v[144:147], v[80:95]
  ds_read_b64_tr_b16 v[236:237], v35 offset:8192
  ds_read_b64_tr_b16 v[238:239], v35 offset:8448
  s_waitcnt lgkmcnt(4)
  v_mfma_f32_32x32x16_bf16 v[80:95], v[228:231], v[148:151], v[80:95]
  ds_read_b64_tr_b16 v[224:225], v32 offset:12288
  ds_read_b64_tr_b16 v[226:227], v32 offset:12544
  s_waitcnt lgkmcnt(4)
  v_mfma_f32_32x32x16_bf16 v[80:95], v[232:235], v[152:155], v[80:95]
  ds_read_b64_tr_b16 v[228:229], v33 offset:12288
  ds_read_b64_tr_b16 v[230:231], v33 offset:12544
  s_waitcnt lgkmcnt(4)
  v_mfma_f32_32x32x16_bf16 v[80:95], v[236:239], v[156:159], v[80:95]
  ds_read_b64_tr_b16 v[232:233], v34 offset:12288
  ds_read_b64_tr_b16 v[234:235], v34 offset:12544
  s_waitcnt lgkmcnt(4)
  v_mfma_f32_32x32x16_bf16 v[80:95], v[224:227], v[160:163], v[80:95]
  ds_read_b64_tr_b16 v[236:237], v35 offset:12288
  ds_read_b64_tr_b16 v[238:239], v35 offset:12544
  s_waitcnt lgkmcnt(4)
  v_mfma_f32_32x32x16_bf16 v[80:95], v[228:231], v[164:167], v[80:95]
  ds_read_b64_tr_b16 v[224:225], v32 offset:16384
  ds_read_b64_tr_b16 v[226:227], v32 offset:16640
  s_waitcnt lgkmcnt(4)
  v_mfma_f32_32x32x16_bf16 v[80:95], v[232:235], v[168:171], v[80:95]
  ds_read_b64_tr_b16 v[228:229], v33 offset:16384
  ds_read_b64_tr_b16 v[230:231], v33 offset:16640
  s_waitcnt lgkmcnt(4)
  v_mfma_f32_32x32x16_bf16 v[80:95], v[236:239], v[172:175], v[80:95]
  ds_read_b64_tr_b16 v[232:233], v34 offset:16384
  ds_read_b64_tr_b16 v[234:235], v34 offset:16640
  s_waitcnt lgkmcnt(4)
  v_mfma_f32_32x32x16_bf16 v[80:95], v[224:227], v[176:179], v[80:95]
  ds_read_b64_tr_b16 v[236:237], v35 offset:16384
  ds_read_b64_tr_b16 v[238:239], v35 offset:16640
  s_waitcnt lgkmcnt(4)
  v_mfma_f32_32x32x16_bf16 v[80:95], v[228:231], v[180:183], v[80:95]
  ds_read_b64_tr_b16 v[224:225], v32 offset:20480
  ds_read_b64_tr_b16 v[226:227], v32 offset:20736
  s_waitcnt lgkmcnt(4)
  v_mfma_f32_32x32x16_bf16 v[80:95], v[232:235], v[184:187], v[80:95]
  ds_read_b64_tr_b16 v[228:229], v33 offset:20480
  ds_read_b64_tr_b16 v[230:231], v33 offset:20736
  s_waitcnt lgkmcnt(4)
  v_mfma_f32_32x32x16_bf16 v[80:95], v[236:239], v[188:191], v[80:95]
  ds_read_b64_tr_b16 v[232:233], v34 offset:20480
  ds_read_b64_tr_b16 v[234:235], v34 offset:20736
  s_waitcnt lgkmcnt(4)
  v_mfma_f32_32x32x16_bf16 v[80:95], v[224:227], v[192:195], v[80:95]
  ds_read_b64_tr_b16 v[236:237], v35 offset:20480
  ds_read_b64_tr_b16 v[238:239], v35 offset:20736
  s_waitcnt lgkmcnt(4)
  v_mfma_f32_32x32x16_bf16 v[80:95], v[228:231], v[196:199], v[80:95]
  ds_read_b64_tr_b16 v[224:225], v32 offset:24576
  ds_read_b64_tr_b16 v[226:227], v32 offset:24832
  s_waitcnt lgkmcnt(4)
  v_mfma_f32_32x32x16_bf16 v[80:95], v[232:235], v[200:203], v[80:95]
  ds_read_b64_tr_b16 v[228:229], v33 offset:24576
  ds_read_b64_tr_b16 v[230:231], v33 offset:24832
  buffer_load_dword v10, v15, s[20:23], s51 offen sc1
  s_waitcnt lgkmcnt(4)
  v_mfma_f32_32x32x16_bf16 v[80:95], v[236:239], v[204:207], v[80:95]
  ds_read_b64_tr_b16 v[232:233], v34 offset:24576
  ds_read_b64_tr_b16 v[234:235], v34 offset:24832
  s_waitcnt lgkmcnt(4)
  v_mfma_f32_32x32x16_bf16 v[80:95], v[224:227], v[208:211], v[80:95]
  ds_read_b64_tr_b16 v[236:237], v35 offset:24576
  ds_read_b64_tr_b16 v[238:239], v35 offset:24832
  s_waitcnt lgkmcnt(4)
  v_mfma_f32_32x32x16_bf16 v[80:95], v[228:231], v[212:215], v[80:95]
  s_waitcnt lgkmcnt(2)
  v_mfma_f32_32x32x16_bf16 v[80:95], v[232:235], v[216:219], v[80:95]
  s_waitcnt lgkmcnt(0)
  v_mfma_f32_32x32x16_bf16 v[80:95], v[236:239], v[220:223], v[80:95]
  s_lshl_b32 s56, 7, s26
  s_lshr_b32 s57, s56, 16
  s_or_b32 s56, s56, s57
  s_and_b32 s56, s56, 0xffff
  s_mov_b32 s59, 0
  s_nop 7
  s_nop 3
  v_pk_fma_f32 v[80:81], v[240:241], v[40:41], v[80:81] op_sel_hi:[1,0,1] neg_lo:[0,1,0] neg_hi:[0,1,0]
  v_pk_fma_f32 v[82:83], v[242:243], v[40:41], v[82:83] op_sel_hi:[1,0,1] neg_lo:[0,1,0] neg_hi:[0,1,0]
  v_pk_fma_f32 v[84:85], v[244:245], v[40:41], v[84:85] op_sel_hi:[1,0,1] neg_lo:[0,1,0] neg_hi:[0,1,0]
  v_pk_fma_f32 v[86:87], v[246:247], v[40:41], v[86:87] op_sel_hi:[1,0,1] neg_lo:[0,1,0] neg_hi:[0,1,0]
  v_pk_fma_f32 v[88:89], v[248:249], v[40:41], v[88:89] op_sel_hi:[1,0,1] neg_lo:[0,1,0] neg_hi:[0,1,0]
  v_pk_fma_f32 v[90:91], v[250:251], v[40:41], v[90:91] op_sel_hi:[1,0,1] neg_lo:[0,1,0] neg_hi:[0,1,0]
  v_pk_fma_f32 v[92:93], v[252:253], v[40:41], v[92:93] op_sel_hi:[1,0,1] neg_lo:[0,1,0] neg_hi:[0,1,0]
  v_pk_fma_f32 v[94:95], v[254:255], v[40:41], v[94:95] op_sel_hi:[1,0,1] neg_lo:[0,1,0] neg_hi:[0,1,0]
  v_pk_mul_f32 v[80:81], v[80:81], v[42:43] op_sel_hi:[1,0]
  v_pk_mul_f32 v[82:83], v[82:83], v[42:43] op_sel_hi:[1,0]
  v_pk_mul_f32 v[84:85], v[84:85], v[42:43] op_sel_hi:[1,0]
  v_pk_mul_f32 v[86:87], v[86:87], v[42:43] op_sel_hi:[1,0]
  v_pk_mul_f32 v[88:89], v[88:89], v[42:43] op_sel_hi:[1,0]
  v_pk_mul_f32 v[90:91], v[90:91], v[42:43] op_sel_hi:[1,0]
  v_pk_mul_f32 v[92:93], v[92:93], v[42:43] op_sel_hi:[1,0]
  v_pk_mul_f32 v[94:95], v[94:95], v[42:43] op_sel_hi:[1,0]
  v_cvt_pk_bf16_f32 v40, v80, v81
  v_cvt_pk_bf16_f32 v41, v82, v83
  v_cvt_pk_bf16_f32 v42, v84, v85
  v_cvt_pk_bf16_f32 v43, v86, v87
  v_cvt_pk_bf16_f32 v44, v88, v89
  v_cvt_pk_bf16_f32 v45, v90, v91
  v_cvt_pk_bf16_f32 v46, v92, v93
  v_cvt_pk_bf16_f32 v47, v94, v95
  v_cndmask_b32_e64 v46, v46, 0, s[34:35]
  v_cndmask_b32_e64 v47, v47, 0, s[34:35]
  ds_write_b128 v6, v[40:43]
  ds_write_b128 v6, v[44:47] offset:1024
  s_waitcnt vmcnt(0)
  v_cmp_eq_u32 vcc, 1, v10
  s_lshr_b32 s57, vcc_lo, 16
  s_and_b32 s57, s57, vcc_lo
  s_mov_b32 s49, 0
  s_andn2_b32 s58, s56, s57
  s_or_b32 s58, s58, s99
  s_cbranch_scc1 L_m_kv1
  s_mov_b32 s49, 1
  s_lshl_b32 s55, s26, 14
  s_add_u32 s55, s55, s54
  buffer_load_dwordx4 v[160:163], v4, s[20:23], s55 offen offset:0
  buffer_load_dwordx4 v[164:167], v4, s[20:23], s55 offen offset:1024
  buffer_load_dwordx4 v[168:171], v4, s[20:23], s55 offen offset:2048
  buffer_load_dwordx4 v[172:175], v4, s[20:23], s55 offen offset:3072
  s_add_u32 s55, s55, 16384
  s_and_b32 s55, s55, 0x3ffff
  s_or_b32 s55, s55, s54
  buffer_load_dwordx4 v[176:179], v4, s[20:23], s55 offen offset:0
  buffer_load_dwordx4 v[180:183], v4, s[20:23], s55 offen offset:1024
  buffer_load_dwordx4 v[184:187], v4, s[20:23], s55 offen offset:2048
  buffer_load_dwordx4 v[188:191], v4, s[20:23], s55 offen offset:3072
  s_add_u32 s55, s55, 16384
  s_and_b32 s55, s55, 0x3ffff
  s_or_b32 s55, s55, s54
  buffer_load_dwordx4 v[192:195], v4, s[20:23], s55 offen offset:0
  buffer_load_dwordx4 v[196:199], v4, s[20:23], s55 offen offset:1024
  buffer_load_dwordx4 v[200:203], v4, s[20:23], s55 offen offset:2048
  buffer_load_dwordx4 v[204:207], v4, s[20:23], s55 offen offset:3072
  s_add_u32 s55, s55, 16384
  s_and_b32 s55, s55, 0x3ffff
  s_or_b32 s55, s55, s54
L_m_kv1:
  s_waitcnt lgkmcnt(0)
  s_barrier
  ds_read_b128 v[16:19], v7 offset:0
  ds_read_b128 v[20:23], v7 offset:1024
  ds_read_b128 v[24:27], v8 offset:0
  ds_read_b128 v[28:31], v8 offset:1024
  ds_read_b128 v[32:35], v9 offset:0
  ds_read_b128 v[36:39], v9 offset:1024
  s_cmp_lg_u32 s49, 0
  s_cbranch_scc1 L_m_go
  s_branch L_fw_3
L_m_main:
  s_lshl_b32 s55, s26, 14
  s_add_u32 s55, s55, s54
  buffer_load_dwordx4 v[160:163], v4, s[20:23], s55 offen offset:0
  buffer_load_dwordx4 v[164:167], v4, s[20:23], s55 offen offset:1024
  buffer_load_dwordx4 v[168:171], v4, s[20:23], s55 offen offset:2048
  buffer_load_dwordx4 v[172:175], v4, s[20:23], s55 offen offset:3072
  s_add_u32 s55, s55, 16384
  s_and_b32 s55, s55, 0x3ffff
  s_or_b32 s55, s55, s54
  buffer_load_dwordx4 v[176:179], v4, s[20:23], s55 offen offset:0
  buffer_load_dwordx4 v[180:183], v4, s[20:23], s55 offen offset:1024
  buffer_load_dwordx4 v[184:187], v4, s[20:23], s55 offen offset:2048
  buffer_load_dwordx4 v[188:191], v4, s[20:23], s55 offen offset:3072
  s_add_u32 s55, s55, 16384
  s_and_b32 s55, s55, 0x3ffff
  s_or_b32 s55, s55, s54
  buffer_load_dwordx4 v[192:195], v4, s[20:23], s55 offen offset:0
  buffer_load_dwordx4 v[196:199], v4, s[20:23], s55 offen offset:1024
  buffer_load_dwordx4 v[200:203], v4, s[20:23], s55 offen offset:2048
  buffer_load_dwordx4 v[204:207], v4, s[20:23], s55 offen offset:3072
  s_add_u32 s55, s55, 16384
  s_and_b32 s55, s55, 0x3ffff
  s_or_b32 s55, s55, s54
L_m_go:
  v_mov_b32 v152, 0
  v_mov_b32 v216, 0
  v_mov_b32 v153, 0
  v_mov_b32 v217, 0
  v_mov_b32 v154, 0
  v_mov_b32 v218, 0
  v_mov_b32 v155, 0
  v_mov_b32 v219, 0
  v_mov_b32 v156, 0
  v_mov_b32 v220, 0
  v_mov_b32 v157, 0
  v_mov_b32 v221, 0
  v_mov_b32 v158, 0
  v_mov_b32 v222, 0
  v_mov_b32 v159, 0
  v_mov_b32 v223, 0
  v_mov_b32 v48, 0
  v_mov_b32 v49, 0
  v_mov_b32 v50, 0
  v_mov_b32 v51, 0
  v_mov_b32 v52, 0
  v_mov_b32 v53, 0
  v_mov_b32 v54, 0
  v_mov_b32 v55, 0
  v_mov_b32 v56, 0
  v_mov_b32 v57, 0
  v_mov_b32 v58, 0
  v_mov_b32 v59, 0
  v_mov_b32 v60, 0
  v_mov_b32 v61, 0
  v_mov_b32 v62, 0
  v_mov_b32 v63, 0
  v_mov_b32 v64, 0
  v_mov_b32 v65, 0
  v_mov_b32 v66, 0
  v_mov_b32 v67, 0
  v_mov_b32 v68, 0
  v_mov_b32 v69, 0
  v_mov_b32 v70, 0
  v_mov_b32 v71, 0
  v_mov_b32 v72, 0
  v_mov_b32 v73, 0
  v_mov_b32 v74, 0
  v_mov_b32 v75, 0
  v_mov_b32 v76, 0
  v_mov_b32 v77, 0
  v_mov_b32 v78, 0
  v_mov_b32 v79, 0
  v_mov_b32 v80, 0
  v_mov_b32 v81, 0
  v_mov_b32 v82, 0
  v_mov_b32 v83, 0
  v_mov_b32 v84, 0
  v_mov_b32 v85, 0
  v_mov_b32 v86, 0
  v_mov_b32 v87, 0
  v_mov_b32 v88, 0
  v_mov_b32 v89, 0
  v_mov_b32 v90, 0
  v_mov_b32 v91, 0
  v_mov_b32 v92, 0
  v_mov_b32 v93, 0
  v_mov_b32 v94, 0
  v_mov_b32 v95, 0
  v_mov_b32 v96, 0
  v_mov_b32 v97, 0
  v_mov_b32 v98, 0
  v_mov_b32 v99, 0
  v_mov_b32 v100, 0
  v_mov_b32 v101, 0
  v_mov_b32 v102, 0
  v_mov_b32 v103, 0
  v_mov_b32 v104, 0
  v_mov_b32 v105, 0
  v_mov_b32 v106, 0
  v_mov_b32 v107, 0
  v_mov_b32 v108, 0
  v_mov_b32 v109, 0
  v_mov_b32 v110, 0
  v_mov_b32 v111, 0
  s_waitcnt vmcnt(8) lgkmcnt(0)
  v_mfma_f32_32x32x16_bf16 v[112:127], v[160:163], v[16:19], 0
  v_mfma_f32_32x32x16_bf16 v[112:127], v[164:167], v[20:23], v[112:127]
  s_nop 7
  s_nop 3
  s_mov_b32 s61, 3
  .p2align 3
L_m_loop:
  v_mfma_f32_32x32x16_bf16 v[128:143], v[160:163], v[24:27], 0
  v_exp_f32 v112, v112
  v_exp_f32 v113, v113
  v_exp_f32 v114, v114
  v_exp_f32 v115, v115
  v_mfma_f32_32x32x16_bf16 v[128:143], v[164:167], v[28:31], v[128:143]
  v_exp_f32 v116, v116
  v_exp_f32 v117, v117
  v_exp_f32 v118, v118
  v_exp_f32 v119, v119
  v_cvt_pk_bf16_f32 v144, v112, v113
  v_cvt_pk_bf16_f32 v145, v114, v115
  v_mfma_f32_32x32x16_bf16 v[96:111], v[216:219], v[152:155], v[96:111]
  v_exp_f32 v120, v120
  v_exp_f32 v121, v121
  v_exp_f32 v122, v122
  v_exp_f32 v123, v123
  v_cvt_pk_bf16_f32 v146, v116, v117
  v_cvt_pk_bf16_f32 v147, v118, v119
  v_mfma_f32_32x32x16_bf16 v[96:111], v[220:223], v[156:159], v[96:111]
  s_bfe_u32 s56, s55, 0x4000e
  s_bitcmp1_b32 s57, s56
  s_cbranch_scc0 L_ke_7
L_kc_6:
  buffer_load_dword v10, v15, s[20:23], s51 offen sc1
  buffer_load_dwordx4 v[208:211], v4, s[20:23], s55 offen offset:0
  buffer_load_dwordx4 v[212:215], v4, s[20:23], s55 offen offset:1024
  buffer_load_dwordx4 v[216:219], v4, s[20:23], s55 offen offset:2048
  buffer_load_dwordx4 v[220:223], v4, s[20:23], s55 offen offset:3072
  s_add_u32 s55, s55, 16384
  s_and_b32 s55, s55, 0x3ffff
  s_or_b32 s55, s55, s54
  s_nop 0
  v_exp_f32 v124, v124
  v_exp_f32 v125, v125
  v_exp_f32 v126, v126
  v_exp_f32 v127, v127
  v_cvt_pk_bf16_f32 v148, v120, v121
  v_cvt_pk_bf16_f32 v149, v122, v123
  v_cvt_pk_bf16_f32 v150, v124, v125
  v_cvt_pk_bf16_f32 v151, v126, v127
  v_mfma_f32_32x32x16_bf16 v[112:127], v[160:163], v[32:35], 0
  v_exp_f32 v128, v128
  v_exp_f32 v129, v129
  v_exp_f32 v130, v130
  v_exp_f32 v131, v131
  v_mfma_f32_32x32x16_bf16 v[112:127], v[164:167], v[36:39], v[112:127]
  v_exp_f32 v132, v132
  v_exp_f32 v133, v133
  v_exp_f32 v134, v134
  v_exp_f32 v135, v135
  v_cvt_pk_bf16_f32 v152, v128, v129
  v_cvt_pk_bf16_f32 v153, v130, v131
  v_mfma_f32_32x32x16_bf16 v[48:63], v[168:171], v[144:147], v[48:63]
  v_exp_f32 v136, v136
  v_exp_f32 v137, v137
  v_exp_f32 v138, v138
  v_exp_f32 v139, v139
  v_cvt_pk_bf16_f32 v154, v132, v133
  v_cvt_pk_bf16_f32 v155, v134, v135
  v_mfma_f32_32x32x16_bf16 v[48:63], v[172:175], v[148:151], v[48:63]
  v_exp_f32 v140, v140
  v_exp_f32 v141, v141
  v_exp_f32 v142, v142
  v_exp_f32 v143, v143
  v_cvt_pk_bf16_f32 v156, v136, v137
  v_cvt_pk_bf16_f32 v157, v138, v139
  v_cvt_pk_bf16_f32 v158, v140, v141
  v_cvt_pk_bf16_f32 v159, v142, v143
  v_mfma_f32_32x32x16_bf16 v[128:143], v[160:163], v[40:43], 0
  v_exp_f32 v112, v112
  v_exp_f32 v113, v113
  v_exp_f32 v114, v114
  v_exp_f32 v115, v115
  v_mfma_f32_32x32x16_bf16 v[128:143], v[164:167], v[44:47], v[128:143]
  v_exp_f32 v116, v116
  v_exp_f32 v117, v117
  v_exp_f32 v118, v118
  v_exp_f32 v119, v119
  v_cvt_pk_bf16_f32 v144, v112, v113
  v_cvt_pk_bf16_f32 v145, v114, v115
  v_mfma_f32_32x32x16_bf16 v[64:79], v[168:171], v[152:155], v[64:79]
  v_exp_f32 v120, v120
  v_exp_f32 v121, v121
  v_exp_f32 v122, v122
  v_exp_f32 v123, v123
  v_cvt_pk_bf16_f32 v146, v116, v117
  v_cvt_pk_bf16_f32 v147, v118, v119
  v_mfma_f32_32x32x16_bf16 v[64:79], v[172:175], v[156:159], v[64:79]
  v_exp_f32_e64 v124, v124
  v_exp_f32 v125, v125
  v_exp_f32 v126, v126
  v_exp_f32 v127, v127
  s_waitcnt vmcnt(9)
  v_cvt_pk_bf16_f32 v148, v120, v121
  v_cvt_pk_bf16_f32 v149, v122, v123
  v_cvt_pk_bf16_f32 v150, v124, v125
  v_cvt_pk_bf16_f32 v151, v126, v127
  v_mfma_f32_32x32x16_bf16 v[112:127], v[176:179], v[16:19], 0
  v_exp_f32 v128, v128
  v_exp_f32 v129, v129
  v_exp_f32 v130, v130
  v_exp_f32 v131, v131
  v_mfma_f32_32x32x16_bf16 v[112:127], v[180:183], v[20:23], v[112:127]
  v_exp_f32 v132, v132
  v_exp_f32 v133, v133
  v_exp_f32 v134, v134
  v_exp_f32 v135, v135
  v_cvt_pk_bf16_f32 v152, v128, v129
  v_cvt_pk_bf16_f32 v153, v130, v131
  v_mfma_f32_32x32x16_bf16 v[80:95], v[168:171], v[144:147], v[80:95]
  v_exp_f32 v136, v136
  v_exp_f32 v137, v137
  v_exp_f32 v138, v138
  v_exp_f32 v139, v139
  v_cvt_pk_bf16_f32 v154, v132, v133
  v_cvt_pk_bf16_f32 v155, v134, v135
  v_mfma_f32_32x32x16_bf16 v[80:95], v[172:175], v[148:151], v[80:95]
  v_exp_f32 v140, v140
  v_exp_f32 v141, v141
  v_exp_f32 v142, v142
  v_exp_f32 v143, v143
  v_cvt_pk_bf16_f32 v156, v136, v137
  v_cvt_pk_bf16_f32 v157, v138, v139
  v_cvt_pk_bf16_f32 v158, v140, v141
  v_cvt_pk_bf16_f32 v159, v142, v143
  v_mfma_f32_32x32x16_bf16 v[128:143], v[176:179], v[24:27], 0
  v_exp_f32 v112, v112
  v_exp_f32 v113, v113
  v_exp_f32 v114, v114
  v_exp_f32 v115, v115
  v_mfma_f32_32x32x16_bf16 v[128:143], v[180:183], v[28:31], v[128:143]
  v_exp_f32 v116, v116
  v_exp_f32 v117, v117
  v_exp_f32 v118, v118
  v_exp_f32 v119, v119
  v_cvt_pk_bf16_f32 v144, v112, v113
  v_cvt_pk_bf16_f32 v145, v114, v115
  v_mfma_f32_32x32x16_bf16 v[96:111], v[168:171], v[152:155], v[96:111]
  v_exp_f32 v120, v120
  v_exp_f32 v121, v121
  v_exp_f32 v122, v122
  v_exp_f32 v123, v123
  v_cvt_pk_bf16_f32 v146, v116, v117
  v_cvt_pk_bf16_f32 v147, v118, v119
  v_mfma_f32_32x32x16_bf16 v[96:111], v[172:175], v[156:159], v[96:111]
  s_bfe_u32 s56, s55, 0x4000e
  s_bitcmp1_b32 s57, s56
  s_cbranch_scc0 L_ke_12
L_kc_11:
  buffer_load_dwordx4 v[160:163], v4, s[20:23], s55 offen offset:0
  buffer_load_dwordx4 v[164:167], v4, s[20:23], s55 offen offset:1024
  buffer_load_dwordx4 v[168:171], v4, s[20:23], s55 offen offset:2048
  buffer_load_dwordx4 v[172:175], v4, s[20:23], s55 offen offset:3072
  s_add_u32 s55, s55, 16384
  s_and_b32 s55, s55, 0x3ffff
  s_or_b32 s55, s55, s54
  s_nop 0
  v_exp_f32 v124, v124
  v_exp_f32 v125, v125
  v_exp_f32 v126, v126
  v_exp_f32 v127, v127
  v_cvt_pk_bf16_f32 v148, v120, v121
  v_cvt_pk_bf16_f32 v149, v122, v123
  v_cvt_pk_bf16_f32 v150, v124, v125
  v_cvt_pk_bf16_f32 v151, v126, v127
  v_mfma_f32_32x32x16_bf16 v[112:127], v[176:179], v[32:35], 0
  v_exp_f32 v128, v128
  v_exp_f32 v129, v129
  v_exp_f32 v130, v130
  v_exp_f32 v131, v131
  v_mfma_f32_32x32x16_bf16 v[112:127], v[180:183], v[36:39], v[112:127]
  v_exp_f32 v132, v132
  v_exp_f32 v133, v133
  v_exp_f32 v134, v134
  v_exp_f32 v135, v135
  v_cvt_pk_bf16_f32 v152, v128, v129
  v_cvt_pk_bf16_f32 v153, v130, v131
  v_mfma_f32_32x32x16_bf16 v[48:63], v[184:187], v[144:147], v[48:63]
  v_exp_f32 v136, v136
  v_exp_f32 v137, v137
  v_exp_f32 v138, v138
  v_exp_f32 v139, v139
  v_cvt_pk_bf16_f32 v154, v132, v133
  v_cvt_pk_bf16_f32 v155, v134, v135
  v_mfma_f32_32x32x16_bf16 v[48:63], v[188:191], v[148:151], v[48:63]
  v_exp_f32 v140, v140
  v_exp_f32 v141, v141
  v_exp_f32 v142, v142
  v_exp_f32 v143, v143
  v_cvt_pk_bf16_f32 v156, v136, v137
  v_cvt_pk_bf16_f32 v157, v138, v139
  v_cvt_pk_bf16_f32 v158, v140, v141
  v_cvt_pk_bf16_f32 v159, v142, v143
  v_mfma_f32_32x32x16_bf16 v[128:143], v[176:179], v[40:43], 0
  v_exp_f32 v112, v112
  v_exp_f32 v113, v113
  v_exp_f32 v114, v114
  v_exp_f32 v115, v115
  v_mfma_f32_32x32x16_bf16 v[128:143], v[180:183], v[44:47], v[128:143]
  v_exp_f32 v116, v116
  v_exp_f32 v117, v117
  v_exp_f32 v118, v118
  v_exp_f32 v119, v119
  v_cvt_pk_bf16_f32 v144, v112, v113
  v_cvt_pk_bf16_f32 v145, v114, v115
  v_mfma_f32_32x32x16_bf16 v[64:79], v[184:187], v[152:155], v[64:79]
  v_exp_f32 v120, v120
  v_exp_f32 v121, v121
  v_exp_f32 v122, v122
  v_exp_f32 v123, v123
  v_cvt_pk_bf16_f32 v146, v116, v117
  v_cvt_pk_bf16_f32 v147, v118, v119
  v_mfma_f32_32x32x16_bf16 v[64:79], v[188:191], v[156:159], v[64:79]
  v_exp_f32_e64 v124, v124
  v_exp_f32 v125, v125
  v_exp_f32 v126, v126
  v_exp_f32 v127, v127
  s_waitcnt vmcnt(8)
  v_cvt_pk_bf16_f32 v148, v120, v121
  v_cvt_pk_bf16_f32 v149, v122, v123
  v_cvt_pk_bf16_f32 v150, v124, v125
  v_cvt_pk_bf16_f32 v151, v126, v127
  v_mfma_f32_32x32x16_bf16 v[112:127], v[192:195], v[16:19], 0
  v_exp_f32 v128, v128
  v_exp_f32 v129, v129
  v_exp_f32 v130, v130
  v_exp_f32 v131, v131
  v_mfma_f32_32x32x16_bf16 v[112:127], v[196:199], v[20:23], v[112:127]
  v_exp_f32 v132, v132
  v_exp_f32 v133, v133
  v_exp_f32 v134, v134
  v_exp_f32 v135, v135
  v_cvt_pk_bf16_f32 v152, v128, v129
  v_cvt_pk_bf16_f32 v153, v130, v131
  v_mfma_f32_32x32x16_bf16 v[80:95], v[184:187], v[144:147], v[80:95]
  v_exp_f32 v136, v136
  v_exp_f32 v137, v137
  v_exp_f32 v138, v138
  v_exp_f32 v139, v139
  v_cvt_pk_bf16_f32 v154, v132, v133
  v_cvt_pk_bf16_f32 v155, v134, v135
  v_mfma_f32_32x32x16_bf16 v[80:95], v[188:191], v[148:151], v[80:95]
  v_exp_f32 v140, v140
  v_exp_f32 v141, v141
  v_exp_f32 v142, v142
  v_exp_f32 v143, v143
  v_cvt_pk_bf16_f32 v156, v136, v137
  v_cvt_pk_bf16_f32 v157, v138, v139
  v_cvt_pk_bf16_f32 v158, v140, v141
  v_cvt_pk_bf16_f32 v159, v142, v143
  v_mfma_f32_32x32x16_bf16 v[128:143], v[192:195], v[24:27], 0
  v_exp_f32 v112, v112
  v_exp_f32 v113, v113
  v_exp_f32 v114, v114
  v_exp_f32 v115, v115
  v_mfma_f32_32x32x16_bf16 v[128:143], v[196:199], v[28:31], v[128:143]
  v_exp_f32 v116, v116
  v_exp_f32 v117, v117
  v_exp_f32 v118, v118
  v_exp_f32 v119, v119
  v_cvt_pk_bf16_f32 v144, v112, v113
  v_cvt_pk_bf16_f32 v145, v114, v115
  v_mfma_f32_32x32x16_bf16 v[96:111], v[184:187], v[152:155], v[96:111]
  v_exp_f32 v120, v120
  v_exp_f32 v121, v121
  v_exp_f32 v122, v122
  v_exp_f32 v123, v123
  v_cvt_pk_bf16_f32 v146, v116, v117
  v_cvt_pk_bf16_f32 v147, v118, v119
  v_mfma_f32_32x32x16_bf16 v[96:111], v[188:191], v[156:159], v[96:111]
  v_cmp_eq_u32 vcc, 1, v10
  s_lshr_b32 s57, vcc_lo, 16
  s_and_b32 s57, s57, vcc_lo
  s_or_b32 s57, s57, s59
  s_bfe_u32 s56, s55, 0x4000e
  s_bitcmp1_b32 s57, s56
  s_cbranch_scc0 L_ke_17
L_kc_16:
  buffer_load_dwordx4 v[176:179], v4, s[20:23], s55 offen offset:0
  buffer_load_dwordx4 v[180:183], v4, s[20:23], s55 offen offset:1024
  buffer_load_dwordx4 v[184:187], v4, s[20:23], s55 offen offset:2048
  buffer_load_dwordx4 v[188:191], v4, s[20:23], s55 offen offset:3072
  s_add_u32 s55, s55, 16384
  s_and_b32 s55, s55, 0x3ffff
  s_or_b32 s55, s55, s54
  s_nop 0
  v_exp_f32 v124, v124
  v_exp_f32 v125, v125
  v_exp_f32 v126, v126
  v_exp_f32 v127, v127
  v_cvt_pk_bf16_f32 v148, v120, v121
  v_cvt_pk_bf16_f32 v149, v122, v123
  v_cvt_pk_bf16_f32 v150, v124, v125
  v_cvt_pk_bf16_f32 v151, v126, v127
  v_mfma_f32_32x32x16_bf16 v[112:127], v[192:195], v[32:35], 0
  v_exp_f32 v128, v128
  v_exp_f32 v129, v129
  v_exp_f32 v130, v130
  v_exp_f32 v131, v131
  v_mfma_f32_32x32x16_bf16 v[112:127], v[196:199], v[36:39], v[112:127]
  v_exp_f32 v132, v132
  v_exp_f32 v133, v133
  v_exp_f32 v134, v134
  v_exp_f32 v135, v135
  v_cvt_pk_bf16_f32 v152, v128, v129
  v_cvt_pk_bf16_f32 v153, v130, v131
  v_mfma_f32_32x32x16_bf16 v[48:63], v[200:203], v[144:147], v[48:63]
  v_exp_f32 v136, v136
  v_exp_f32 v137, v137
  v_exp_f32 v138, v138
  v_exp_f32 v139, v139
  v_cvt_pk_bf16_f32 v154, v132, v133
  v_cvt_pk_bf16_f32 v155, v134, v135
  v_mfma_f32_32x32x16_bf16 v[48:63], v[204:207], v[148:151], v[48:63]
  v_exp_f32 v140, v140
  v_exp_f32 v141, v141
  v_exp_f32 v142, v142
  v_exp_f32 v143, v143
  v_cvt_pk_bf16_f32 v156, v136, v137
  v_cvt_pk_bf16_f32 v157, v138, v139
  v_cvt_pk_bf16_f32 v158, v140, v141
  v_cvt_pk_bf16_f32 v159, v142, v143
  v_mfma_f32_32x32x16_bf16 v[128:143], v[192:195], v[40:43], 0
  v_exp_f32 v112, v112
  v_exp_f32 v113, v113
  v_exp_f32 v114, v114
  v_exp_f32 v115, v115
  v_mfma_f32_32x32x16_bf16 v[128:143], v[196:199], v[44:47], v[128:143]
  v_exp_f32 v116, v116
  v_exp_f32 v117, v117
  v_exp_f32 v118, v118
  v_exp_f32 v119, v119
  v_cvt_pk_bf16_f32 v144, v112, v113
  v_cvt_pk_bf16_f32 v145, v114, v115
  v_mfma_f32_32x32x16_bf16 v[64:79], v[200:203], v[152:155], v[64:79]
  v_exp_f32 v120, v120
  v_exp_f32 v121, v121
  v_exp_f32 v122, v122
  v_exp_f32 v123, v123
  v_cvt_pk_bf16_f32 v146, v116, v117
  v_cvt_pk_bf16_f32 v147, v118, v119
  v_mfma_f32_32x32x16_bf16 v[64:79], v[204:207], v[156:159], v[64:79]
  v_exp_f32_e64 v124, v124
  v_exp_f32 v125, v125
  v_exp_f32 v126, v126
  v_exp_f32 v127, v127
  s_waitcnt vmcnt(8)
  v_cvt_pk_bf16_f32 v148, v120, v121
  v_cvt_pk_bf16_f32 v149, v122, v123
  v_cvt_pk_bf16_f32 v150, v124, v125
  v_cvt_pk_bf16_f32 v151, v126, v127
  v_mfma_f32_32x32x16_bf16 v[112:127], v[208:211], v[16:19], 0
  v_exp_f32 v128, v128
  v_exp_f32 v129, v129
  v_exp_f32 v130, v130
  v_exp_f32 v131, v131
  v_mfma_f32_32x32x16_bf16 v[112:127], v[212:215], v[20:23], v[112:127]
  v_exp_f32 v132, v132
  v_exp_f32 v133, v133
  v_exp_f32 v134, v134
  v_exp_f32 v135, v135
  v_cvt_pk_bf16_f32 v152, v128, v129
  v_cvt_pk_bf16_f32 v153, v130, v131
  v_mfma_f32_32x32x16_bf16 v[80:95], v[200:203], v[144:147], v[80:95]
  v_exp_f32 v136, v136
  v_exp_f32 v137, v137
  v_exp_f32 v138, v138
  v_exp_f32 v139, v139
  v_cvt_pk_bf16_f32 v154, v132, v133
  v_cvt_pk_bf16_f32 v155, v134, v135
  v_mfma_f32_32x32x16_bf16 v[80:95], v[204:207], v[148:151], v[80:95]
  v_exp_f32 v140, v140
  v_exp_f32 v141, v141
  v_exp_f32 v142, v142
  v_exp_f32 v143, v143
  v_cvt_pk_bf16_f32 v156, v136, v137
  v_cvt_pk_bf16_f32 v157, v138, v139
  v_cvt_pk_bf16_f32 v158, v140, v141
  v_cvt_pk_bf16_f32 v159, v142, v143
  v_mfma_f32_32x32x16_bf16 v[128:143], v[208:211], v[24:27], 0
  v_exp_f32 v112, v112
  v_exp_f32 v113, v113
  v_exp_f32 v114, v114
  v_exp_f32 v115, v115
  v_mfma_f32_32x32x16_bf16 v[128:143], v[212:215], v[28:31], v[128:143]
  v_exp_f32 v116, v116
  v_exp_f32 v117, v117
  v_exp_f32 v118, v118
  v_exp_f32 v119, v119
  v_cvt_pk_bf16_f32 v144, v112, v113
  v_cvt_pk_bf16_f32 v145, v114, v115
  v_mfma_f32_32x32x16_bf16 v[96:111], v[200:203], v[152:155], v[96:111]
  v_exp_f32 v120, v120
  v_exp_f32 v121, v121
  v_exp_f32 v122, v122
  v_exp_f32 v123, v123
  v_cvt_pk_bf16_f32 v146, v116, v117
  v_cvt_pk_bf16_f32 v147, v118, v119
  v_mfma_f32_32x32x16_bf16 v[96:111], v[204:207], v[156:159], v[96:111]
  s_bfe_u32 s56, s55, 0x4000e
  s_bitcmp1_b32 s57, s56
  s_cbranch_scc0 L_ke_22
L_kc_21:
  buffer_load_dwordx4 v[192:195], v4, s[20:23], s55 offen offset:0
  buffer_load_dwordx4 v[196:199], v4, s[20:23], s55 offen offset:1024
  buffer_load_dwordx4 v[200:203], v4, s[20:23], s55 offen offset:2048
  buffer_load_dwordx4 v[204:207], v4, s[20:23], s55 offen offset:3072
  s_add_u32 s55, s55, 16384
  s_and_b32 s55, s55, 0x3ffff
  s_or_b32 s55, s55, s54
  s_nop 0
  v_exp_f32 v124, v124
  v_exp_f32 v125, v125
  v_exp_f32 v126, v126
  v_exp_f32 v127, v127
  v_cvt_pk_bf16_f32 v148, v120, v121
  v_cvt_pk_bf16_f32 v149, v122, v123
  v_cvt_pk_bf16_f32 v150, v124, v125
  v_cvt_pk_bf16_f32 v151, v126, v127
  v_mfma_f32_32x32x16_bf16 v[112:127], v[208:211], v[32:35], 0
  v_exp_f32 v128, v128
  v_exp_f32 v129, v129
  v_exp_f32 v130, v130
  v_exp_f32 v131, v131
  v_mfma_f32_32x32x16_bf16 v[112:127], v[212:215], v[36:39], v[112:127]
  v_exp_f32 v132, v132
  v_exp_f32 v133, v133
  v_exp_f32 v134, v134
  v_exp_f32 v135, v135
  v_cvt_pk_bf16_f32 v152, v128, v129
  v_cvt_pk_bf16_f32 v153, v130, v131
  v_mfma_f32_32x32x16_bf16 v[48:63], v[216:219], v[144:147], v[48:63]
  v_exp_f32 v136, v136
  v_exp_f32 v137, v137
  v_exp_f32 v138, v138
  v_exp_f32 v139, v139
  v_cvt_pk_bf16_f32 v154, v132, v133
  v_cvt_pk_bf16_f32 v155, v134, v135
  v_mfma_f32_32x32x16_bf16 v[48:63], v[220:223], v[148:151], v[48:63]
  v_exp_f32 v140, v140
  v_exp_f32 v141, v141
  v_exp_f32 v142, v142
  v_exp_f32 v143, v143
  v_cvt_pk_bf16_f32 v156, v136, v137
  v_cvt_pk_bf16_f32 v157, v138, v139
  v_cvt_pk_bf16_f32 v158, v140, v141
  v_cvt_pk_bf16_f32 v159, v142, v143
  v_mfma_f32_32x32x16_bf16 v[128:143], v[208:211], v[40:43], 0
  v_exp_f32 v112, v112
  v_exp_f32 v113, v113
  v_exp_f32 v114, v114
  v_exp_f32 v115, v115
  v_mfma_f32_32x32x16_bf16 v[128:143], v[212:215], v[44:47], v[128:143]
  v_exp_f32 v116, v116
  v_exp_f32 v117, v117
  v_exp_f32 v118, v118
  v_exp_f32 v119, v119
  v_cvt_pk_bf16_f32 v144, v112, v113
  v_cvt_pk_bf16_f32 v145, v114, v115
  v_mfma_f32_32x32x16_bf16 v[64:79], v[216:219], v[152:155], v[64:79]
  v_exp_f32 v120, v120
  v_exp_f32 v121, v121
  v_exp_f32 v122, v122
  v_exp_f32 v123, v123
  v_cvt_pk_bf16_f32 v146, v116, v117
  v_cvt_pk_bf16_f32 v147, v118, v119
  v_mfma_f32_32x32x16_bf16 v[64:79], v[220:223], v[156:159], v[64:79]
  v_exp_f32_e64 v124, v124
  v_exp_f32 v125, v125
  v_exp_f32 v126, v126
  v_exp_f32 v127, v127
  s_waitcnt vmcnt(8)
  v_cvt_pk_bf16_f32 v148, v120, v121
  v_cvt_pk_bf16_f32 v149, v122, v123
  v_cvt_pk_bf16_f32 v150, v124, v125
  v_cvt_pk_bf16_f32 v151, v126, v127
  v_mfma_f32_32x32x16_bf16 v[112:127], v[160:163], v[16:19], 0
  v_exp_f32 v128, v128
  v_exp_f32 v129, v129
  v_exp_f32 v130, v130
  v_exp_f32 v131, v131
  v_mfma_f32_32x32x16_bf16 v[112:127], v[164:167], v[20:23], v[112:127]
  v_exp_f32 v132, v132
  v_exp_f32 v133, v133
  v_exp_f32 v134, v134
  v_exp_f32 v135, v135
  v_cvt_pk_bf16_f32 v152, v128, v129
  v_cvt_pk_bf16_f32 v153, v130, v131
  v_mfma_f32_32x32x16_bf16 v[80:95], v[216:219], v[144:147], v[80:95]
  v_exp_f32 v136, v136
  v_exp_f32 v137, v137
  v_exp_f32 v138, v138
  v_exp_f32 v139, v139
  v_cvt_pk_bf16_f32 v154, v132, v133
  v_cvt_pk_bf16_f32 v155, v134, v135
  v_mfma_f32_32x32x16_bf16 v[80:95], v[220:223], v[148:151], v[80:95]
  v_exp_f32 v140, v140
  v_exp_f32 v141, v141
  v_exp_f32 v142, v142
  v_exp_f32 v143, v143
  v_cvt_pk_bf16_f32 v156, v136, v137
  v_cvt_pk_bf16_f32 v157, v138, v139
  v_cvt_pk_bf16_f32 v158, v140, v141
  v_cvt_pk_bf16_f32 v159, v142, v143
  s_sub_u32 s61, s61, 1
  s_cmp_lg_u32 s61, 0
  s_cbranch_scc1 L_m_loop
  s_nop 0
  v_mfma_f32_32x32x16_bf16 v[128:143], v[160:163], v[24:27], 0
  v_exp_f32 v112, v112
  v_exp_f32 v113, v113
  v_exp_f32 v114, v114
  v_exp_f32 v115, v115
  v_mfma_f32_32x32x16_bf16 v[128:143], v[164:167], v[28:31], v[128:143]
  v_exp_f32 v116, v116
  v_exp_f32 v117, v117
  v_exp_f32 v118, v118
  v_exp_f32 v119, v119
  v_cvt_pk_bf16_f32 v144, v112, v113
  v_cvt_pk_bf16_f32 v145, v114, v115
  v_mfma_f32_32x32x16_bf16 v[96:111], v[216:219], v[152:155], v[96:111]
  v_exp_f32 v120, v120
  v_exp_f32 v121, v121
  v_exp_f32 v122, v122
  v_exp_f32 v123, v123
  v_cvt_pk_bf16_f32 v146, v116, v117
  v_cvt_pk_bf16_f32 v147, v118, v119
  v_mfma_f32_32x32x16_bf16 v[96:111], v[220:223], v[156:159], v[96:111]
  s_bfe_u32 s56, s55, 0x4000e
  s_bitcmp1_b32 s57, s56
  s_cbranch_scc0 L_ke_27
L_kc_26:
  buffer_load_dwordx4 v[208:211], v4, s[20:23], s55 offen offset:0
  buffer_load_dwordx4 v[212:215], v4, s[20:23], s55 offen offset:1024
  buffer_load_dwordx4 v[216:219], v4, s[20:23], s55 offen offset:2048
  buffer_load_dwordx4 v[220:223], v4, s[20:23], s55 offen offset:3072
  s_add_u32 s55, s55, 16384
  s_and_b32 s55, s55, 0x3ffff
  s_or_b32 s55, s55, s54
  s_nop 0
  v_exp_f32 v124, v124
  v_exp_f32 v125, v125
  v_exp_f32 v126, v126
  v_exp_f32 v127, v127
  v_cvt_pk_bf16_f32 v148, v120, v121
  v_cvt_pk_bf16_f32 v149, v122, v123
  v_cvt_pk_bf16_f32 v150, v124, v125
  v_cvt_pk_bf16_f32 v151, v126, v127
  v_mfma_f32_32x32x16_bf16 v[112:127], v[160:163], v[32:35], 0
  v_exp_f32 v128, v128
  v_exp_f32 v129, v129
  v_exp_f32 v130, v130
  v_exp_f32 v131, v131
  v_mfma_f32_32x32x16_bf16 v[112:127], v[164:167], v[36:39], v[112:127]
  v_exp_f32 v132, v132
  v_exp_f32 v133, v133
  v_exp_f32 v134, v134
  v_exp_f32 v135, v135
  v_cvt_pk_bf16_f32 v152, v128, v129
  v_cvt_pk_bf16_f32 v153, v130, v131
  v_mfma_f32_32x32x16_bf16 v[48:63], v[168:171], v[144:147], v[48:63]
  v_exp_f32 v136, v136
  v_exp_f32 v137, v137
  v_exp_f32 v138, v138
  v_exp_f32 v139, v139
  v_cvt_pk_bf16_f32 v154, v132, v133
  v_cvt_pk_bf16_f32 v155, v134, v135
  v_mfma_f32_32x32x16_bf16 v[48:63], v[172:175], v[148:151], v[48:63]
  v_exp_f32 v140, v140
  v_exp_f32 v141, v141
  v_exp_f32 v142, v142
  v_exp_f32 v143, v143
  v_cvt_pk_bf16_f32 v156, v136, v137
  v_cvt_pk_bf16_f32 v157, v138, v139
  v_cvt_pk_bf16_f32 v158, v140, v141
  v_cvt_pk_bf16_f32 v159, v142, v143
  v_mfma_f32_32x32x16_bf16 v[128:143], v[160:163], v[40:43], 0
  v_exp_f32 v112, v112
  v_exp_f32 v113, v113
  v_exp_f32 v114, v114
  v_exp_f32 v115, v115
  v_mfma_f32_32x32x16_bf16 v[128:143], v[164:167], v[44:47], v[128:143]
  v_exp_f32 v116, v116
  v_exp_f32 v117, v117
  v_exp_f32 v118, v118
  v_exp_f32 v119, v119
  v_cvt_pk_bf16_f32 v144, v112, v113
  v_cvt_pk_bf16_f32 v145, v114, v115
  v_mfma_f32_32x32x16_bf16 v[64:79], v[168:171], v[152:155], v[64:79]
  v_exp_f32 v120, v120
  v_exp_f32 v121, v121
  v_exp_f32 v122, v122
  v_exp_f32 v123, v123
  v_cvt_pk_bf16_f32 v146, v116, v117
  v_cvt_pk_bf16_f32 v147, v118, v119
  v_mfma_f32_32x32x16_bf16 v[64:79], v[172:175], v[156:159], v[64:79]
  v_exp_f32_e64 v124, v124
  v_exp_f32 v125, v125
  v_exp_f32 v126, v126
  v_exp_f32 v127, v127
  s_waitcnt vmcnt(8)
  v_cvt_pk_bf16_f32 v148, v120, v121
  v_cvt_pk_bf16_f32 v149, v122, v123
  v_cvt_pk_bf16_f32 v150, v124, v125
  v_cvt_pk_bf16_f32 v151, v126, v127
  v_mfma_f32_32x32x16_bf16 v[112:127], v[176:179], v[16:19], 0
  v_exp_f32 v128, v128
  v_exp_f32 v129, v129
  v_exp_f32 v130, v130
  v_exp_f32 v131, v131
  v_mfma_f32_32x32x16_bf16 v[112:127], v[180:183], v[20:23], v[112:127]
  v_exp_f32 v132, v132
  v_exp_f32 v133, v133
  v_exp_f32 v134, v134
  v_exp_f32 v135, v135
  v_cvt_pk_bf16_f32 v152, v128, v129
  v_cvt_pk_bf16_f32 v153, v130, v131
  v_mfma_f32_32x32x16_bf16 v[80:95], v[168:171], v[144:147], v[80:95]
  v_exp_f32 v136, v136
  v_exp_f32 v137, v137
  v_exp_f32 v138, v138
  v_exp_f32 v139, v139
  v_cvt_pk_bf16_f32 v154, v132, v133
  v_cvt_pk_bf16_f32 v155, v134, v135
  v_mfma_f32_32x32x16_bf16 v[80:95], v[172:175], v[148:151], v[80:95]
  v_exp_f32 v140, v140
  v_exp_f32 v141, v141
  v_exp_f32 v142, v142
  v_exp_f32 v143, v143
  v_cvt_pk_bf16_f32 v156, v136, v137
  v_cvt_pk_bf16_f32 v157, v138, v139
  v_cvt_pk_bf16_f32 v158, v140, v141
  v_cvt_pk_bf16_f32 v159, v142, v143
  v_mfma_f32_32x32x16_bf16 v[128:143], v[176:179], v[24:27], 0
  v_exp_f32 v112, v112
  v_exp_f32 v113, v113
  v_exp_f32 v114, v114
  v_exp_f32 v115, v115
  v_mfma_f32_32x32x16_bf16 v[128:143], v[180:183], v[28:31], v[128:143]
  v_exp_f32 v116, v116
  v_exp_f32 v117, v117
  v_exp_f32 v118, v118
  v_exp_f32 v119, v119
  v_cvt_pk_bf16_f32 v144, v112, v113
  v_cvt_pk_bf16_f32 v145, v114, v115
  v_mfma_f32_32x32x16_bf16 v[96:111], v[168:171], v[152:155], v[96:111]
  v_exp_f32 v120, v120
  v_exp_f32 v121, v121
  v_exp_f32 v122, v122
  v_exp_f32 v123, v123
  v_cvt_pk_bf16_f32 v146, v116, v117
  v_cvt_pk_bf16_f32 v147, v118, v119
  v_mfma_f32_32x32x16_bf16 v[96:111], v[172:175], v[156:159], v[96:111]
  v_exp_f32 v124, v124
  v_exp_f32 v125, v125
  v_exp_f32 v126, v126
  v_exp_f32 v127, v127
  v_cvt_pk_bf16_f32 v148, v120, v121
  v_cvt_pk_bf16_f32 v149, v122, v123
  v_cvt_pk_bf16_f32 v150, v124, v125
  v_cvt_pk_bf16_f32 v151, v126, v127
  v_mfma_f32_32x32x16_bf16 v[112:127], v[176:179], v[32:35], 0
  v_exp_f32 v128, v128
  v_exp_f32 v129, v129
  v_exp_f32 v130, v130
  v_exp_f32 v131, v131
  v_mfma_f32_32x32x16_bf16 v[112:127], v[180:183], v[36:39], v[112:127]
  v_exp_f32 v132, v132
  v_exp_f32 v133, v133
  v_exp_f32 v134, v134
  v_exp_f32 v135, v135
  v_cvt_pk_bf16_f32 v152, v128, v129
  v_cvt_pk_bf16_f32 v153, v130, v131
  v_mfma_f32_32x32x16_bf16 v[48:63], v[184:187], v[144:147], v[48:63]
  v_exp_f32 v136, v136
  v_exp_f32 v137, v137
  v_exp_f32 v138, v138
  v_exp_f32 v139, v139
  v_cvt_pk_bf16_f32 v154, v132, v133
  v_cvt_pk_bf16_f32 v155, v134, v135
  v_mfma_f32_32x32x16_bf16 v[48:63], v[188:191], v[148:151], v[48:63]
  v_exp_f32 v140, v140
  v_exp_f32 v141, v141
  v_exp_f32 v142, v142
  v_exp_f32 v143, v143
  v_cvt_pk_bf16_f32 v156, v136, v137
  v_cvt_pk_bf16_f32 v157, v138, v139
  v_cvt_pk_bf16_f32 v158, v140, v141
  v_cvt_pk_bf16_f32 v159, v142, v143
  v_mfma_f32_32x32x16_bf16 v[128:143], v[176:179], v[40:43], 0
  v_exp_f32 v112, v112
  v_exp_f32 v113, v113
  v_exp_f32 v114, v114
  v_exp_f32 v115, v115
  v_mfma_f32_32x32x16_bf16 v[128:143], v[180:183], v[44:47], v[128:143]
  v_exp_f32 v116, v116
  v_exp_f32 v117, v117
  v_exp_f32 v118, v118
  v_exp_f32 v119, v119
  v_cvt_pk_bf16_f32 v144, v112, v113
  v_cvt_pk_bf16_f32 v145, v114, v115
  v_mfma_f32_32x32x16_bf16 v[64:79], v[184:187], v[152:155], v[64:79]
  v_exp_f32 v120, v120
  v_exp_f32 v121, v121
  v_exp_f32 v122, v122
  v_exp_f32 v123, v123
  v_cvt_pk_bf16_f32 v146, v116, v117
  v_cvt_pk_bf16_f32 v147, v118, v119
  v_mfma_f32_32x32x16_bf16 v[64:79], v[188:191], v[156:159], v[64:79]
  v_exp_f32_e64 v124, v124
  v_exp_f32 v125, v125
  v_exp_f32 v126, v126
  v_exp_f32 v127, v127
  s_waitcnt vmcnt(4)
  v_cvt_pk_bf16_f32 v148, v120, v121
  v_cvt_pk_bf16_f32 v149, v122, v123
  v_cvt_pk_bf16_f32 v150, v124, v125
  v_cvt_pk_bf16_f32 v151, v126, v127
  v_mfma_f32_32x32x16_bf16 v[112:127], v[192:195], v[16:19], 0
  v_exp_f32 v128, v128
  v_exp_f32 v129, v129
  v_exp_f32 v130, v130
  v_exp_f32 v131, v131
  v_mfma_f32_32x32x16_bf16 v[112:127], v[196:199], v[20:23], v[112:127]
  v_exp_f32 v132, v132
  v_exp_f32 v133, v133
  v_exp_f32 v134, v134
  v_exp_f32 v135, v135
  v_cvt_pk_bf16_f32 v152, v128, v129
  v_cvt_pk_bf16_f32 v153, v130, v131
  v_mfma_f32_32x32x16_bf16 v[80:95], v[184:187], v[144:147], v[80:95]
  v_exp_f32 v136, v136
  v_exp_f32 v137, v137
  v_exp_f32 v138, v138
  v_exp_f32 v139, v139
  v_cvt_pk_bf16_f32 v154, v132, v133
  v_cvt_pk_bf16_f32 v155, v134, v135
  v_mfma_f32_32x32x16_bf16 v[80:95], v[188:191], v[148:151], v[80:95]
  v_exp_f32 v140, v140
  v_exp_f32 v141, v141
  v_exp_f32 v142, v142
  v_exp_f32 v143, v143
  v_cvt_pk_bf16_f32 v156, v136, v137
  v_cvt_pk_bf16_f32 v157, v138, v139
  v_cvt_pk_bf16_f32 v158, v140, v141
  v_cvt_pk_bf16_f32 v159, v142, v143
  v_mfma_f32_32x32x16_bf16 v[128:143], v[192:195], v[24:27], 0
  v_exp_f32 v112, v112
  v_exp_f32 v113, v113
  v_exp_f32 v114, v114
  v_exp_f32 v115, v115
  v_mfma_f32_32x32x16_bf16 v[128:143], v[196:199], v[28:31], v[128:143]
  v_exp_f32 v116, v116
  v_exp_f32 v117, v117
  v_exp_f32 v118, v118
  v_exp_f32 v119, v119
  v_cvt_pk_bf16_f32 v144, v112, v113
  v_cvt_pk_bf16_f32 v145, v114, v115
  v_mfma_f32_32x32x16_bf16 v[96:111], v[184:187], v[152:155], v[96:111]
  v_exp_f32 v120, v120
  v_exp_f32 v121, v121
  v_exp_f32 v122, v122
  v_exp_f32 v123, v123
  v_cvt_pk_bf16_f32 v146, v116, v117
  v_cvt_pk_bf16_f32 v147, v118, v119
  v_mfma_f32_32x32x16_bf16 v[96:111], v[188:191], v[156:159], v[96:111]
  v_exp_f32 v124, v124
  v_exp_f32 v125, v125
  v_exp_f32 v126, v126
  v_exp_f32 v127, v127
  v_cvt_pk_bf16_f32 v148, v120, v121
  v_cvt_pk_bf16_f32 v149, v122, v123
  v_cvt_pk_bf16_f32 v150, v124, v125
  v_cvt_pk_bf16_f32 v151, v126, v127
  v_mfma_f32_32x32x16_bf16 v[112:127], v[192:195], v[32:35], 0
  v_exp_f32 v128, v128
  v_exp_f32 v129, v129
  v_exp_f32 v130, v130
  v_exp_f32 v131, v131
  v_mfma_f32_32x32x16_bf16 v[112:127], v[196:199], v[36:39], v[112:127]
  v_exp_f32 v132, v132
  v_exp_f32 v133, v133
  v_exp_f32 v134, v134
  v_exp_f32 v135, v135
  v_cvt_pk_bf16_f32 v152, v128, v129
  v_cvt_pk_bf16_f32 v153, v130, v131
  v_mfma_f32_32x32x16_bf16 v[48:63], v[200:203], v[144:147], v[48:63]
  v_exp_f32 v136, v136
  v_exp_f32 v137, v137
  v_exp_f32 v138, v138
  v_exp_f32 v139, v139
  v_cvt_pk_bf16_f32 v154, v132, v133
  v_cvt_pk_bf16_f32 v155, v134, v135
  v_mfma_f32_32x32x16_bf16 v[48:63], v[204:207], v[148:151], v[48:63]
  v_exp_f32 v140, v140
  v_exp_f32 v141, v141
  v_exp_f32 v142, v142
  v_exp_f32 v143, v143
  v_cvt_pk_bf16_f32 v156, v136, v137
  v_cvt_pk_bf16_f32 v157, v138, v139
  v_cvt_pk_bf16_f32 v158, v140, v141
  v_cvt_pk_bf16_f32 v159, v142, v143
  v_mfma_f32_32x32x16_bf16 v[128:143], v[192:195], v[40:43], 0
  v_exp_f32 v112, v112
  v_exp_f32 v113, v113
  v_exp_f32 v114, v114
  v_exp_f32 v115, v115
  v_mfma_f32_32x32x16_bf16 v[128:143], v[196:199], v[44:47], v[128:143]
  v_exp_f32 v116, v116
  v_exp_f32 v117, v117
  v_exp_f32 v118, v118
  v_exp_f32 v119, v119
  v_cvt_pk_bf16_f32 v144, v112, v113
  v_cvt_pk_bf16_f32 v145, v114, v115
  v_mfma_f32_32x32x16_bf16 v[64:79], v[200:203], v[152:155], v[64:79]
  v_exp_f32 v120, v120
  v_exp_f32 v121, v121
  v_exp_f32 v122, v122
  v_exp_f32 v123, v123
  v_cvt_pk_bf16_f32 v146, v116, v117
  v_cvt_pk_bf16_f32 v147, v118, v119
  v_mfma_f32_32x32x16_bf16 v[64:79], v[204:207], v[156:159], v[64:79]
  v_exp_f32_e64 v124, v124
  v_exp_f32 v125, v125
  v_exp_f32 v126, v126
  v_exp_f32 v127, v127
  s_waitcnt vmcnt(0)
  v_cvt_pk_bf16_f32 v148, v120, v121
  v_cvt_pk_bf16_f32 v149, v122, v123
  v_cvt_pk_bf16_f32 v150, v124, v125
  v_cvt_pk_bf16_f32 v151, v126, v127
  v_mfma_f32_32x32x16_bf16 v[112:127], v[208:211], v[16:19], 0
  v_exp_f32 v128, v128
  v_exp_f32 v129, v129
  v_exp_f32 v130, v130
  v_exp_f32 v131, v131
  v_mfma_f32_32x32x16_bf16 v[112:127], v[212:215], v[20:23], v[112:127]
  v_exp_f32 v132, v132
  v_exp_f32 v133, v133
  v_exp_f32 v134, v134
  v_exp_f32 v135, v135
  v_cvt_pk_bf16_f32 v152, v128, v129
  v_cvt_pk_bf16_f32 v153, v130, v131
  v_mfma_f32_32x32x16_bf16 v[80:95], v[200:203], v[144:147], v[80:95]
  v_exp_f32 v136, v136
  v_exp_f32 v137, v137
  v_exp_f32 v138, v138
  v_exp_f32 v139, v139
  v_cvt_pk_bf16_f32 v154, v132, v133
  v_cvt_pk_bf16_f32 v155, v134, v135
  v_mfma_f32_32x32x16_bf16 v[80:95], v[204:207], v[148:151], v[80:95]
  v_exp_f32 v140, v140
  v_exp_f32 v141, v141
  v_exp_f32 v142, v142
  v_exp_f32 v143, v143
  v_cvt_pk_bf16_f32 v156, v136, v137
  v_cvt_pk_bf16_f32 v157, v138, v139
  v_cvt_pk_bf16_f32 v158, v140, v141
  v_cvt_pk_bf16_f32 v159, v142, v143
  v_mfma_f32_32x32x16_bf16 v[128:143], v[208:211], v[24:27], 0
  v_exp_f32 v112, v112
  v_exp_f32 v113, v113
  v_exp_f32 v114, v114
  v_exp_f32 v115, v115
  v_mfma_f32_32x32x16_bf16 v[128:143], v[212:215], v[28:31], v[128:143]
  v_exp_f32 v116, v116
  v_exp_f32 v117, v117
  v_exp_f32 v118, v118
  v_exp_f32 v119, v119
  v_cvt_pk_bf16_f32 v144, v112, v113
  v_cvt_pk_bf16_f32 v145, v114, v115
  v_mfma_f32_32x32x16_bf16 v[96:111], v[200:203], v[152:155], v[96:111]
  v_exp_f32 v120, v120
  v_exp_f32 v121, v121
  v_exp_f32 v122, v122
  v_exp_f32 v123, v123
  v_cvt_pk_bf16_f32 v146, v116, v117
  v_cvt_pk_bf16_f32 v147, v118, v119
  v_mfma_f32_32x32x16_bf16 v[96:111], v[204:207], v[156:159], v[96:111]
  v_exp_f32 v124, v124
  v_exp_f32 v125, v125
  v_exp_f32 v126, v126
  v_exp_f32 v127, v127
  v_cvt_pk_bf16_f32 v148, v120, v121
  v_cvt_pk_bf16_f32 v149, v122, v123
  v_cvt_pk_bf16_f32 v150, v124, v125
  v_cvt_pk_bf16_f32 v151, v126, v127
  v_mfma_f32_32x32x16_bf16 v[112:127], v[208:211], v[32:35], 0
  v_exp_f32 v128, v128
  v_exp_f32 v129, v129
  v_exp_f32 v130, v130
  v_exp_f32 v131, v131
  v_mfma_f32_32x32x16_bf16 v[112:127], v[212:215], v[36:39], v[112:127]
  v_exp_f32 v132, v132
  v_exp_f32 v133, v133
  v_exp_f32 v134, v134
  v_exp_f32 v135, v135
  v_cvt_pk_bf16_f32 v152, v128, v129
  v_cvt_pk_bf16_f32 v153, v130, v131
  v_mfma_f32_32x32x16_bf16 v[48:63], v[216:219], v[144:147], v[48:63]
  v_exp_f32 v136, v136
  v_exp_f32 v137, v137
  v_exp_f32 v138, v138
  v_exp_f32 v139, v139
  v_cvt_pk_bf16_f32 v154, v132, v133
  v_cvt_pk_bf16_f32 v155, v134, v135
  v_mfma_f32_32x32x16_bf16 v[48:63], v[220:223], v[148:151], v[48:63]
  v_exp_f32 v140, v140
  v_exp_f32 v141, v141
  v_exp_f32 v142, v142
  v_exp_f32 v143, v143
  v_cvt_pk_bf16_f32 v156, v136, v137
  v_cvt_pk_bf16_f32 v157, v138, v139
  v_cvt_pk_bf16_f32 v158, v140, v141
  v_cvt_pk_bf16_f32 v159, v142, v143
  v_mfma_f32_32x32x16_bf16 v[128:143], v[208:211], v[40:43], 0
  v_exp_f32 v112, v112
  v_exp_f32 v113, v113
  v_exp_f32 v114, v114
  v_exp_f32 v115, v115
  v_mfma_f32_32x32x16_bf16 v[128:143], v[212:215], v[44:47], v[128:143]
  v_exp_f32 v116, v116
  v_exp_f32 v117, v117
  v_exp_f32 v118, v118
  v_exp_f32 v119, v119
  v_cvt_pk_bf16_f32 v144, v112, v113
  v_cvt_pk_bf16_f32 v145, v114, v115
  v_mfma_f32_32x32x16_bf16 v[64:79], v[216:219], v[152:155], v[64:79]
  ds_write_b128 v11, v[48:51] offset:0
  ds_write_b128 v11, v[52:55] offset:1024
  v_exp_f32 v120, v120
  v_exp_f32 v121, v121
  v_exp_f32 v122, v122
  v_exp_f32 v123, v123
  v_cvt_pk_bf16_f32 v146, v116, v117
  v_cvt_pk_bf16_f32 v147, v118, v119
  v_mfma_f32_32x32x16_bf16 v[64:79], v[220:223], v[156:159], v[64:79]
  ds_write_b128 v11, v[56:59] offset:2048
  ds_write_b128 v11, v[60:63] offset:3072
  v_exp_f32 v124, v124
  v_exp_f32 v125, v125
  v_exp_f32 v126, v126
  v_exp_f32 v127, v127
  v_cvt_pk_bf16_f32 v148, v120, v121
  v_cvt_pk_bf16_f32 v149, v122, v123
  v_cvt_pk_bf16_f32 v150, v124, v125
  v_cvt_pk_bf16_f32 v151, v126, v127
  v_exp_f32 v128, v128
  v_exp_f32 v129, v129
  v_exp_f32 v130, v130
  v_exp_f32 v131, v131
  v_exp_f32 v132, v132
  v_exp_f32 v133, v133
  v_exp_f32 v134, v134
  v_exp_f32 v135, v135
  v_cvt_pk_bf16_f32 v152, v128, v129
  v_cvt_pk_bf16_f32 v153, v130, v131
  v_mfma_f32_32x32x16_bf16 v[80:95], v[216:219], v[144:147], v[80:95]
  ds_write_b128 v12, v[64:67] offset:0
  ds_write_b128 v12, v[68:71] offset:1024
  v_exp_f32 v136, v136
  v_exp_f32 v137, v137
  v_exp_f32 v138, v138
  v_exp_f32 v139, v139
  v_cvt_pk_bf16_f32 v154, v132, v133
  v_cvt_pk_bf16_f32 v155, v134, v135
  v_mfma_f32_32x32x16_bf16 v[80:95], v[220:223], v[148:151], v[80:95]
  ds_write_b128 v12, v[72:75] offset:2048
  ds_write_b128 v12, v[76:79] offset:3072
  v_exp_f32 v140, v140
  v_exp_f32 v141, v141
  v_exp_f32 v142, v142
  v_exp_f32 v143, v143
  v_cvt_pk_bf16_f32 v156, v136, v137
  v_cvt_pk_bf16_f32 v157, v138, v139
  v_cvt_pk_bf16_f32 v158, v140, v141
  v_cvt_pk_bf16_f32 v159, v142, v143
  s_nop 1
  v_mfma_f32_32x32x16_bf16 v[96:111], v[216:219], v[152:155], v[96:111]
  v_mfma_f32_32x32x16_bf16 v[96:111], v[220:223], v[156:159], v[96:111]
  ds_write_b128 v13, v[80:83] offset:0
  ds_write_b128 v13, v[84:87] offset:1024
  ds_write_b128 v13, v[88:91] offset:2048
  ds_write_b128 v13, v[92:95] offset:3072
  s_waitcnt lgkmcnt(0)
  s_barrier
  ds_read_b128 v[48:51], v14 offset:0
  ds_read_b128 v[52:55], v14 offset:1024
  ds_read_b128 v[56:59], v14 offset:2048
  ds_read_b128 v[60:63], v14 offset:3072
  ds_read_b128 v[64:67], v14 offset:4096
  ds_read_b128 v[68:71], v14 offset:5120
  ds_read_b128 v[72:75], v14 offset:6144
  ds_read_b128 v[76:79], v14 offset:7168
  ds_read_b128 v[80:83], v14 offset:8192
  ds_read_b128 v[84:87], v14 offset:9216
  ds_read_b128 v[88:91], v14 offset:10240
  ds_read_b128 v[92:95], v14 offset:11264
  s_lshl_b32 s53, s26, 2
  s_add_u32 s53, s53, s3
  s_lshl_b32 s52, s53, 4
  s_add_u32 s52, s52, s27
  s_lshl_b32 s52, s52, 11
  s_lshl_b32 s59, s53, 7
  s_lshl_b32 s53, s27, 2
  s_add_u32 s59, s59, s53
  s_add_u32 s59, s59, 0x7fc000
  s_mov_b32 s57, 0x21800000
  s_mov_b32 s58, 0x71800000
  s_waitcnt lgkmcnt(4)
  v_add_f32 v48, v48, v64
  v_add_f32 v49, v49, v65
  v_add_f32 v50, v50, v66
  v_add_f32 v51, v51, v67
  v_add_f32 v52, v52, v68
  v_add_f32 v53, v53, v69
  v_add_f32 v54, v54, v70
  v_add_f32 v55, v55, v71
  v_add_f32 v56, v56, v72
  v_add_f32 v57, v57, v73
  v_add_f32 v58, v58, v74
  v_add_f32 v59, v59, v75
  v_add_f32 v60, v60, v76
  v_add_f32 v61, v61, v77
  v_add_f32 v62, v62, v78
  v_add_f32 v63, v63, v79
  s_waitcnt lgkmcnt(0)
  v_add_f32 v96, v96, v80
  v_add_f32 v97, v97, v81
  v_add_f32 v98, v98, v82
  v_add_f32 v99, v99, v83
  v_add_f32 v100, v100, v84
  v_add_f32 v101, v101, v85
  v_add_f32 v102, v102, v86
  v_add_f32 v103, v103, v87
  v_add_f32 v104, v104, v88
  v_add_f32 v105, v105, v89
  v_add_f32 v106, v106, v90
  v_add_f32 v107, v107, v91
  v_add_f32 v108, v108, v92
  v_add_f32 v109, v109, v93
  v_add_f32 v110, v110, v94
  v_add_f32 v111, v111, v95
  v_add_f32 v108, v108, v60
  v_mov_b32 v6, v108
  v_mov_b32 v7, v108
  v_add_f32 v96, v96, v48
  v_add_f32 v97, v97, v49
  v_permlane32_swap_b32 v6, v7
  v_add_f32 v98, v98, v50
  v_add_f32 v99, v99, v51
  v_add_f32 v100, v100, v52
  v_add_f32 v101, v101, v53
  v_add_f32 v102, v102, v54
  v_add_f32 v103, v103, v55
  v_add_f32 v104, v104, v56
  v_add_f32 v105, v105, v57
  v_add_f32 v106, v106, v58
  v_add_f32 v107, v107, v59
  v_add_f32 v109, v109, v61
  v_add_f32 v110, v110, v62
  v_add_f32 v111, v111, v63
  v_cmp_lt_f32 vcc, s57, v7
  v_cmp_gt_f32 s[62:63], s58, v7
  v_rcp_f32 v7, v7
  s_and_b64 vcc, vcc, s[62:63]
  s_cmp_eq_u64 vcc, exec
  s_cbranch_scc1 L_m_ok1
  v_mov_b32 v9, 159744
  v_mov_b32 v10, 1
  ds_write_b32 v9, v10
L_m_ok1:
  v_mul_f32 v96, v7, v96
  v_mul_f32 v97, v7, v97
  v_mul_f32 v98, v7, v98
  v_mul_f32 v99, v7, v99
  v_mul_f32 v100, v7, v100
  v_mul_f32 v101, v7, v101
  v_mul_f32 v102, v7, v102
  v_mul_f32 v103, v7, v103
  v_mul_f32 v104, v7, v104
  v_mul_f32 v105, v7, v105
  v_mul_f32 v106, v7, v106
  v_mul_f32 v107, v7, v107
  v_mul_f32 v108, v7, v108
  v_mul_f32 v109, v7, v109
  v_mul_f32 v110, v7, v110
  v_mul_f32 v111, v7, v111
  v_cndmask_b32_e64 v108, v108, 0, s[34:35]
  v_cndmask_b32_e64 v109, v109, 0, s[34:35]
  v_cndmask_b32_e64 v110, v110, 0, s[34:35]
  v_cndmask_b32_e64 v111, v111, 0, s[34:35]
  v_cvt_pk_bf16_f32 v240, v96, v97
  v_cvt_pk_bf16_f32 v241, v98, v99
  v_cvt_pk_bf16_f32 v242, v100, v101
  v_cvt_pk_bf16_f32 v243, v102, v103
  v_cvt_pk_bf16_f32 v244, v104, v105
  v_cvt_pk_bf16_f32 v245, v106, v107
  v_cvt_pk_bf16_f32 v246, v108, v109
  v_cvt_pk_bf16_f32 v247, v110, v111
  buffer_store_dwordx4 v[240:243], v4, s[20:23], s52 offen sc1
  buffer_store_dwordx4 v[244:247], v4, s[20:23], s52 offen offset:1024 sc1
  s_cmp_lg_u32 s101, 0
  s_cbranch_scc1 L_m_nopre
  s_lshl_b32 s33, s29, 15
  s_add_u32 s33, s33, 65536
  v_add_u32 v6, s33, v5
  v_xor_b32 v7, 64, v6
  ds_read_b64_tr_b16 v[112:113], v6 offset:0
  ds_read_b64_tr_b16 v[114:115], v6 offset:1024
  ds_read_b64_tr_b16 v[116:117], v7 offset:0
  ds_read_b64_tr_b16 v[118:119], v7 offset:1024
  ds_read_b64_tr_b16 v[120:121], v6 offset:2048
  ds_read_b64_tr_b16 v[122:123], v6 offset:3072
  ds_read_b64_tr_b16 v[124:125], v7 offset:2048
  ds_read_b64_tr_b16 v[126:127], v7 offset:3072
  ds_read_b64_tr_b16 v[128:129], v6 offset:4096
  ds_read_b64_tr_b16 v[130:131], v6 offset:5120
  ds_read_b64_tr_b16 v[132:133], v7 offset:4096
  ds_read_b64_tr_b16 v[134:135], v7 offset:5120
  ds_read_b64_tr_b16 v[136:137], v6 offset:6144
  ds_read_b64_tr_b16 v[138:139], v6 offset:7168
  ds_read_b64_tr_b16 v[140:141], v7 offset:6144
  ds_read_b64_tr_b16 v[142:143], v7 offset:7168
  ds_read_b64_tr_b16 v[144:145], v6 offset:8192
  ds_read_b64_tr_b16 v[146:147], v6 offset:9216
  ds_read_b64_tr_b16 v[148:149], v7 offset:8192
  ds_read_b64_tr_b16 v[150:151], v7 offset:9216
  ds_read_b64_tr_b16 v[152:153], v6 offset:10240
  ds_read_b64_tr_b16 v[154:155], v6 offset:11264
  ds_read_b64_tr_b16 v[156:157], v7 offset:10240
  ds_read_b64_tr_b16 v[158:159], v7 offset:11264
  ds_read_b64_tr_b16 v[160:161], v6 offset:12288
  ds_read_b64_tr_b16 v[162:163], v6 offset:13312
  ds_read_b64_tr_b16 v[164:165], v7 offset:12288
  ds_read_b64_tr_b16 v[166:167], v7 offset:13312
  ds_read_b64_tr_b16 v[168:169], v6 offset:14336
  ds_read_b64_tr_b16 v[170:171], v6 offset:15360
  ds_read_b64_tr_b16 v[172:173], v7 offset:14336
  ds_read_b64_tr_b16 v[174:175], v7 offset:15360
  ds_read_b64_tr_b16 v[176:177], v6 offset:16384
  ds_read_b64_tr_b16 v[178:179], v6 offset:17408
  ds_read_b64_tr_b16 v[180:181], v7 offset:16384
  ds_read_b64_tr_b16 v[182:183], v7 offset:17408
  ds_read_b64_tr_b16 v[184:185], v6 offset:18432
  ds_read_b64_tr_b16 v[186:187], v6 offset:19456
  ds_read_b64_tr_b16 v[188:189], v7 offset:18432
  ds_read_b64_tr_b16 v[190:191], v7 offset:19456
  ds_read_b64_tr_b16 v[192:193], v6 offset:20480
  ds_read_b64_tr_b16 v[194:195], v6 offset:21504
  ds_read_b64_tr_b16 v[196:197], v7 offset:20480
  ds_read_b64_tr_b16 v[198:199], v7 offset:21504
  ds_read_b64_tr_b16 v[200:201], v6 offset:22528
  ds_read_b64_tr_b16 v[202:203], v6 offset:23552
  ds_read_b64_tr_b16 v[204:205], v7 offset:22528
  ds_read_b64_tr_b16 v[206:207], v7 offset:23552
  ds_read_b64_tr_b16 v[208:209], v6 offset:24576
  ds_read_b64_tr_b16 v[210:211], v6 offset:25600
  ds_read_b64_tr_b16 v[212:213], v7 offset:24576
  ds_read_b64_tr_b16 v[214:215], v7 offset:25600
  ds_read_b64_tr_b16 v[216:217], v6 offset:26624
  ds_read_b64_tr_b16 v[218:219], v6 offset:27648
  ds_read_b64_tr_b16 v[220:221], v7 offset:26624
  ds_read_b64_tr_b16 v[222:223], v7 offset:27648
  ds_read_b64_tr_b16 v[224:225], v6 offset:28672
  ds_read_b64_tr_b16 v[226:227], v6 offset:29696
  ds_read_b64_tr_b16 v[228:229], v7 offset:28672
  ds_read_b64_tr_b16 v[230:231], v7 offset:29696
  ds_read_b64_tr_b16 v[232:233], v6 offset:30720
  ds_read_b64_tr_b16 v[234:235], v6 offset:31744
  ds_read_b64_tr_b16 v[236:237], v7 offset:30720
  ds_read_b64_tr_b16 v[238:239], v7 offset:31744
L_m_nopre:
  s_waitcnt lgkmcnt(0)
  s_barrier
  v_mov_b32 v9, 159744
  ds_read_b32 v10, v9
  s_waitcnt lgkmcnt(0)
  v_readfirstlane_b32 s52, v10
  v_mov_b32 v8, 0
  v_mov_b32 v9, 1
  s_nop 1
  s_andn2_b32 s52, s52, s60
  s_cmp_lg_u32 s52, 0
  s_cbranch_scc1 L_m_slow
  s_waitcnt vmcnt(0)
  buffer_store_dword v9, v8, s[20:23], s59 offen sc1
  s_lshl_b32 s52, s27, 8
  s_lshl_b32 s53, s26, 2
  s_add_u32 s52, s52, s53
  s_add_u32 s52, s52, s3
  s_lshl_b32 s52, s52, 2
  s_add_u32 s52, s52, 0x7f8200
  v_mov_b32 v9, 1
  s_cmp_lg_u32 s99, 0
  s_cbranch_scc1 L_ps_31
  buffer_store_dword v9, v8, s[20:23], s52 offen
L_pb_32:
  s_cmp_lg_u32 s101, 0
  s_cbranch_scc1 L_m_fin
  s_lshl_b32 s46, s30, 7
  s_lshl_b32 s47, s29, 5
  s_add_u32 s46, s46, s47
  s_add_u32 s46, s46, 0x7fc000
  v_and_b32 v9, 7, v1
  v_lshlrev_b32 v9, 2, v9
  v_mul_u32_u24 v12, 896, v2
  v_lshl_add_u32 v12, v3, 3, v12
  s_mov_b32 s16, s4
  s_mov_b32 s17, s5
  s_mov_b32 s18, 0x1c0000
  s_mov_b32 s19, 0x00020000
  buffer_load_dwordx2 v[248:249], v12, s[16:19], s32 offen offset:0
  buffer_load_dwordx2 v[250:251], v12, s[16:19], s32 offen offset:16
  buffer_load_dwordx2 v[252:253], v12, s[16:19], s32 offen offset:32
  buffer_load_dwordx2 v[254:255], v12, s[16:19], s32 offen offset:48
  s_mul_i32 s44, s30, 28
  s_lshl_b32 s45, s31, 1
  s_add_u32 s44, s44, s45
  s_lshl_b32 s44, s44, 10
  s_lshl_b32 s45, s30, 15
  s_lshl_b32 s47, s29, 14
  s_add_u32 s45, s45, s47
L_poll_33:
  buffer_load_dword v10, v9, s[20:23], s46 offen sc1
  s_waitcnt vmcnt(0)
  v_and_b32 v11, 0xff, v10
  v_cmp_le_u32 vcc, 1, v11
  s_cmp_eq_u64 vcc, exec
  s_cbranch_scc1 L_pd_34
  s_sub_u32 s100, s100, 1
  s_cbranch_scc0 L_poll_33
  s_mov_b32 s100, 0
L_pd_34:
  buffer_load_dwordx4 v[16:19], v4, s[20:23], s45 offen offset:0 sc1
  buffer_load_dwordx4 v[20:23], v4, s[20:23], s45 offen offset:1024 sc1
  buffer_load_dwordx4 v[24:27], v4, s[20:23], s45 offen offset:2048 sc1
  buffer_load_dwordx4 v[28:31], v4, s[20:23], s45 offen offset:3072 sc1
  s_add_u32 s45, s45, 4096
  buffer_load_dwordx4 v[32:35], v4, s[20:23], s45 offen offset:0 sc1
  buffer_load_dwordx4 v[36:39], v4, s[20:23], s45 offen offset:1024 sc1
  buffer_load_dwordx4 v[40:43], v4, s[20:23], s45 offen offset:2048 sc1
  buffer_load_dwordx4 v[44:47], v4, s[20:23], s45 offen offset:3072 sc1
  s_add_u32 s45, s45, 4096
  buffer_load_dwordx4 v[48:51], v4, s[20:23], s45 offen offset:0 sc1
  buffer_load_dwordx4 v[52:55], v4, s[20:23], s45 offen offset:1024 sc1
  buffer_load_dwordx4 v[56:59], v4, s[20:23], s45 offen offset:2048 sc1
  buffer_load_dwordx4 v[60:63], v4, s[20:23], s45 offen offset:3072 sc1
  s_add_u32 s45, s45, 4096
  buffer_load_dwordx4 v[64:67], v4, s[20:23], s45 offen offset:0 sc1
  buffer_load_dwordx4 v[68:71], v4, s[20:23], s45 offen offset:1024 sc1
  buffer_load_dwordx4 v[72:75], v4, s[20:23], s45 offen offset:2048 sc1
  buffer_load_dwordx4 v[76:79], v4, s[20:23], s45 offen offset:3072 sc1
  s_add_u32 s45, s45, 4096
  s_lshl_b32 s33, s3, 12
  s_add_u32 s33, s33, 94208
  v_add_u32 v8, s33, v4
  s_xor_b32 s33, s3, 2
  s_lshl_b32 s33, s33, 12
  s_add_u32 s33, s33, 94208
  v_add_u32 v9, s33, v4
  s_mul_i32 s46, s30, 3584
  s_lshl_b32 s47, s31, 8
  s_add_u32 s46, s46, s47
  s_add_u32 s46, s46, 0x7c0000
  s_mov_b32 s16, s14
  s_mov_b32 s17, s15
  s_mov_b32 s18, 0x1c0000
  s_mov_b32 s19, 0x00020000
  s_lshl_b32 s33, s97, 4
  s_lshl_b32 s47, s3, 2
  s_add_u32 s33, s33, s47
  v_mov_b32 v15, s33
  s_waitcnt vmcnt(15)
  v_mfma_f32_32x32x16_bf16 v[96:111], v[116:119], v[16:19], 0
  v_mfma_f32_32x32x16_bf16 v[80:95], v[112:115], v[16:19], 0
  s_waitcnt vmcnt(14)
  v_mfma_f32_32x32x16_bf16 v[96:111], v[124:127], v[20:23], v[96:111]
  v_mfma_f32_32x32x16_bf16 v[80:95], v[120:123], v[20:23], v[80:95]
  s_waitcnt vmcnt(13)
  v_mfma_f32_32x32x16_bf16 v[96:111], v[132:135], v[24:27], v[96:111]
  v_mfma_f32_32x32x16_bf16 v[80:95], v[128:131], v[24:27], v[80:95]
  s_waitcnt vmcnt(12)
  v_mfma_f32_32x32x16_bf16 v[96:111], v[140:143], v[28:31], v[96:111]
  v_mfma_f32_32x32x16_bf16 v[80:95], v[136:139], v[28:31], v[80:95]
  s_waitcnt vmcnt(11)
  v_mfma_f32_32x32x16_bf16 v[96:111], v[148:151], v[32:35], v[96:111]
  v_mfma_f32_32x32x16_bf16 v[80:95], v[144:147], v[32:35], v[80:95]
  s_waitcnt vmcnt(10)
  v_mfma_f32_32x32x16_bf16 v[96:111], v[156:159], v[36:39], v[96:111]
  v_mfma_f32_32x32x16_bf16 v[80:95], v[152:155], v[36:39], v[80:95]
  s_waitcnt vmcnt(9)
  v_mfma_f32_32x32x16_bf16 v[96:111], v[164:167], v[40:43], v[96:111]
  v_mfma_f32_32x32x16_bf16 v[80:95], v[160:163], v[40:43], v[80:95]
  s_waitcnt vmcnt(8)
  v_mfma_f32_32x32x16_bf16 v[96:111], v[172:175], v[44:47], v[96:111]
  v_mfma_f32_32x32x16_bf16 v[80:95], v[168:171], v[44:47], v[80:95]
  s_waitcnt vmcnt(7)
  v_mfma_f32_32x32x16_bf16 v[96:111], v[180:183], v[48:51], v[96:111]
  v_mfma_f32_32x32x16_bf16 v[80:95], v[176:179], v[48:51], v[80:95]
  s_waitcnt vmcnt(6)
  v_mfma_f32_32x32x16_bf16 v[96:111], v[188:191], v[52:55], v[96:111]
  v_mfma_f32_32x32x16_bf16 v[80:95], v[184:187], v[52:55], v[80:95]
  s_waitcnt vmcnt(5)
  v_mfma_f32_32x32x16_bf16 v[96:111], v[196:199], v[56:59], v[96:111]
  v_mfma_f32_32x32x16_bf16 v[80:95], v[192:195], v[56:59], v[80:95]
  s_waitcnt vmcnt(4)
  v_mfma_f32_32x32x16_bf16 v[96:111], v[204:207], v[60:63], v[96:111]
  v_mfma_f32_32x32x16_bf16 v[80:95], v[200:203], v[60:63], v[80:95]
  s_waitcnt vmcnt(3)
  v_mfma_f32_32x32x16_bf16 v[96:111], v[212:215], v[64:67], v[96:111]
  v_mfma_f32_32x32x16_bf16 v[80:95], v[208:211], v[64:67], v[80:95]
  s_waitcnt vmcnt(2)
  v_mfma_f32_32x32x16_bf16 v[96:111], v[220:223], v[68:71], v[96:111]
  v_mfma_f32_32x32x16_bf16 v[80:95], v[216:219], v[68:71], v[80:95]
  s_waitcnt vmcnt(1)
  v_mfma_f32_32x32x16_bf16 v[96:111], v[228:231], v[72:75], v[96:111]
  v_mfma_f32_32x32x16_bf16 v[80:95], v[224:227], v[72:75], v[80:95]
  s_waitcnt vmcnt(0)
  v_mfma_f32_32x32x16_bf16 v[96:111], v[236:239], v[76:79], v[96:111]
  v_mfma_f32_32x32x16_bf16 v[80:95], v[232:235], v[76:79], v[80:95]
  v_lshlrev_b32 v16, 16, v248
  v_and_b32 v17, 0xffff0000, v248
  v_lshlrev_b32 v18, 16, v249
  v_and_b32 v19, 0xffff0000, v249
  v_lshlrev_b32 v20, 16, v250
  v_and_b32 v21, 0xffff0000, v250
  v_lshlrev_b32 v22, 16, v251
  v_and_b32 v23, 0xffff0000, v251
  v_lshlrev_b32 v24, 16, v252
  v_and_b32 v25, 0xffff0000, v252
  v_lshlrev_b32 v26, 16, v253
  v_and_b32 v27, 0xffff0000, v253
  v_lshlrev_b32 v28, 16, v254
  v_and_b32 v29, 0xffff0000, v254
  v_lshlrev_b32 v30, 16, v255
  v_and_b32 v31, 0xffff0000, v255
  ds_write_b128 v8, v[96:99] offset:0
  ds_write_b128 v8, v[100:103] offset:1024
  ds_write_b128 v8, v[104:107] offset:2048
  ds_write_b128 v8, v[108:111] offset:3072
  s_waitcnt lgkmcnt(0)
  s_barrier
  ds_read_b128 v[48:51], v9 offset:0
  ds_read_b128 v[52:55], v9 offset:1024
  ds_read_b128 v[56:59], v9 offset:2048
  ds_read_b128 v[60:63], v9 offset:3072
  v_lshlrev_b32 v9, 3, v2
  v_mov_b32 v8, 0x3f803f80
  v_mov_b32 v64, 0
  v_mov_b32 v65, 0
  s_waitcnt lgkmcnt(3)
  v_add_f32 v80, v80, v48
  v_add_f32 v81, v81, v49
  v_add_f32 v82, v82, v50
  v_add_f32 v83, v83, v51
  s_waitcnt lgkmcnt(2)
  v_add_f32 v84, v84, v52
  v_add_f32 v85, v85, v53
  v_add_f32 v86, v86, v54
  v_add_f32 v87, v87, v55
  s_waitcnt lgkmcnt(1)
  v_add_f32 v88, v88, v56
  v_add_f32 v89, v89, v57
  v_add_f32 v90, v90, v58
  v_add_f32 v91, v91, v59
  s_waitcnt lgkmcnt(0)
  v_add_f32 v92, v92, v60
  v_add_f32 v93, v93, v61
  v_add_f32 v94, v94, v62
  v_add_f32 v95, v95, v63
  v_cvt_pk_bf16_f32 v248, v80, v81
  v_cvt_pk_bf16_f32 v249, v82, v83
  v_cvt_pk_bf16_f32 v250, v84, v85
  v_cvt_pk_bf16_f32 v251, v86, v87
  v_cvt_pk_bf16_f32 v252, v88, v89
  v_cvt_pk_bf16_f32 v253, v90, v91
  v_cvt_pk_bf16_f32 v254, v92, v93
  v_cvt_pk_bf16_f32 v255, v94, v95
  v_lshlrev_b32 v80, 16, v248
  v_and_b32 v81, 0xffff0000, v248
  v_lshlrev_b32 v82, 16, v249
  v_and_b32 v83, 0xffff0000, v249
  v_lshlrev_b32 v84, 16, v250
  v_and_b32 v85, 0xffff0000, v250
  v_lshlrev_b32 v86, 16, v251
  v_and_b32 v87, 0xffff0000, v251
  v_lshlrev_b32 v88, 16, v252
  v_and_b32 v89, 0xffff0000, v252
  v_lshlrev_b32 v90, 16, v253
  v_and_b32 v91, 0xffff0000, v253
  v_lshlrev_b32 v92, 16, v254
  v_and_b32 v93, 0xffff0000, v254
  v_lshlrev_b32 v94, 16, v255
  v_and_b32 v95, 0xffff0000, v255
  v_add_f32 v80, v80, v16
  v_add_f32 v81, v81, v17
  v_add_f32 v82, v82, v18
  v_add_f32 v83, v83, v19
  v_add_f32 v84, v84, v20
  v_add_f32 v85, v85, v21
  v_add_f32 v86, v86, v22
  v_add_f32 v87, v87, v23
  v_add_f32 v88, v88, v24
  v_add_f32 v89, v89, v25
  v_add_f32 v90, v90, v26
  v_add_f32 v91, v91, v27
  v_add_f32 v92, v92, v28
  v_add_f32 v93, v93, v29
  v_add_f32 v94, v94, v30
  v_add_f32 v95, v95, v31
  v_cvt_pk_bf16_f32 v248, v80, v81
  v_cvt_pk_bf16_f32 v249, v82, v83
  v_cvt_pk_bf16_f32 v250, v84, v85
  v_cvt_pk_bf16_f32 v251, v86, v87
  v_cvt_pk_bf16_f32 v252, v88, v89
  v_cvt_pk_bf16_f32 v253, v90, v91
  v_cvt_pk_bf16_f32 v254, v92, v93
  v_cvt_pk_bf16_f32 v255, v94, v95
  buffer_store_dwordx4 v[248:251], v4, s[16:19], s44 offen
  buffer_store_dwordx4 v[252:255], v4, s[16:19], s44 offen offset:1024
  v_dot2_f32_bf16 v64, v248, v8, v64
  v_dot2_f32_bf16 v65, v248, v248, v65
  v_dot2_f32_bf16 v64, v249, v8, v64
  v_dot2_f32_bf16 v65, v249, v249, v65
  v_dot2_f32_bf16 v64, v250, v8, v64
  v_dot2_f32_bf16 v65, v250, v250, v65
  v_dot2_f32_bf16 v64, v251, v8, v64
  v_dot2_f32_bf16 v65, v251, v251, v65
  v_dot2_f32_bf16 v64, v252, v8, v64
  v_dot2_f32_bf16 v65, v252, v252, v65
  v_dot2_f32_bf16 v64, v253, v8, v64
  v_dot2_f32_bf16 v65, v253, v253, v65
  v_dot2_f32_bf16 v64, v254, v8, v64
  v_dot2_f32_bf16 v65, v254, v254, v65
  v_dot2_f32_bf16 v64, v255, v8, v64
  v_dot2_f32_bf16 v65, v255, v255, v65
  s_nop 2
  v_mov_b32 v16, v64
  s_nop 1
  v_permlane32_swap_b32 v16, v64
  s_nop 1
  v_add_f32 v64, v64, v16
  v_mov_b32 v16, v65
  s_nop 1
  v_permlane32_swap_b32 v16, v65
  s_nop 1
  v_add_f32 v65, v65, v16
  v_mov_b32 v200, v64
  v_mov_b32 v201, v65
  buffer_store_dwordx2 v[200:201], v9, s[20:23], s46 offen
  v_xor_b32 v6, 64, v5
  s_lshl_b32 s33, s3, 12
  v_add_u32 v192, s33, v5
  v_add_u32 v193, s33, v6
  v_add_u32 v194, 102400, v192
  v_add_u32 v195, 102400, v193
  s_add_u32 s33, s33, 147456
  s_cmp_eq_u32 s3, 3
  s_cselect_b32 s33, 126976, s33
  v_add_u32 v196, s33, v5
  v_add_u32 v197, s33, v6
  ds_read_b64_tr_b16 v[112:113], v196 offset:0
  ds_read_b64_tr_b16 v[114:115], v196 offset:1024
  ds_read_b64_tr_b16 v[116:117], v197 offset:0
  ds_read_b64_tr_b16 v[118:119], v197 offset:1024
  ds_read_b64_tr_b16 v[120:121], v196 offset:2048
  ds_read_b64_tr_b16 v[122:123], v196 offset:3072
  ds_read_b64_tr_b16 v[124:125], v197 offset:2048
  ds_read_b64_tr_b16 v[126:127], v197 offset:3072
  ds_read_b64_tr_b16 v[96:97], v194 offset:8192
  ds_read_b64_tr_b16 v[98:99], v194 offset:9216
  ds_read_b64_tr_b16 v[100:101], v195 offset:8192
  ds_read_b64_tr_b16 v[102:103], v195 offset:9216
  ds_read_b64_tr_b16 v[104:105], v194 offset:10240
  ds_read_b64_tr_b16 v[106:107], v194 offset:11264
  ds_read_b64_tr_b16 v[108:109], v195 offset:10240
  ds_read_b64_tr_b16 v[110:111], v195 offset:11264
  ds_read_b64_tr_b16 v[80:81], v192 offset:32768
  ds_read_b64_tr_b16 v[82:83], v192 offset:33792
  ds_read_b64_tr_b16 v[84:85], v193 offset:32768
  ds_read_b64_tr_b16 v[86:87], v193 offset:33792
  ds_read_b64_tr_b16 v[88:89], v192 offset:34816
  ds_read_b64_tr_b16 v[90:91], v192 offset:35840
  ds_read_b64_tr_b16 v[92:93], v193 offset:34816
  ds_read_b64_tr_b16 v[94:95], v193 offset:35840
  s_waitcnt vmcnt(0)
  v_mov_b32 v14, 1
  s_cmp_lg_u32 s99, 0
  s_cbranch_scc1 L_ps_35
  buffer_store_dword v14, v15, s[20:23], s98 offen
L_pb_36:
  s_setprio 0
  ds_read_b64_tr_b16 v[64:65], v192 offset:16384
  ds_read_b64_tr_b16 v[66:67], v192 offset:17408
  ds_read_b64_tr_b16 v[68:69], v193 offset:16384
  ds_read_b64_tr_b16 v[70:71], v193 offset:17408
  ds_read_b64_tr_b16 v[72:73], v192 offset:18432
  ds_read_b64_tr_b16 v[74:75], v192 offset:19456
  ds_read_b64_tr_b16 v[76:77], v193 offset:18432
  ds_read_b64_tr_b16 v[78:79], v193 offset:19456
  ds_read_b64_tr_b16 v[48:49], v192 offset:0
  ds_read_b64_tr_b16 v[50:51], v192 offset:1024
  ds_read_b64_tr_b16 v[52:53], v193 offset:0
  ds_read_b64_tr_b16 v[54:55], v193 offset:1024
  ds_read_b64_tr_b16 v[56:57], v192 offset:2048
  ds_read_b64_tr_b16 v[58:59], v192 offset:3072
  ds_read_b64_tr_b16 v[60:61], v193 offset:2048
  ds_read_b64_tr_b16 v[62:63], v193 offset:3072
  ds_read_b64_tr_b16 v[32:33], v194 offset:28672
  ds_read_b64_tr_b16 v[34:35], v194 offset:29696
  ds_read_b64_tr_b16 v[36:37], v195 offset:28672
  ds_read_b64_tr_b16 v[38:39], v195 offset:29696
  ds_read_b64_tr_b16 v[40:41], v194 offset:30720
  ds_read_b64_tr_b16 v[42:43], v194 offset:31744
  ds_read_b64_tr_b16 v[44:45], v195 offset:30720
  ds_read_b64_tr_b16 v[46:47], v195 offset:31744
  ds_read_b64_tr_b16 v[16:17], v192 offset:49152
  ds_read_b64_tr_b16 v[18:19], v192 offset:50176
  ds_read_b64_tr_b16 v[20:21], v193 offset:49152
  ds_read_b64_tr_b16 v[22:23], v193 offset:50176
  ds_read_b64_tr_b16 v[24:25], v192 offset:51200
  ds_read_b64_tr_b16 v[26:27], v192 offset:52224
  ds_read_b64_tr_b16 v[28:29], v193 offset:51200
  ds_read_b64_tr_b16 v[30:31], v193 offset:52224
  s_lshl_b32 s50, s95, 1
  s_and_b32 s51, s96, 1
  s_add_u32 s50, s50, s51
  s_mul_i32 s51, s94, 114688
  s_lshl_b32 s49, s3, 10
  s_add_u32 s51, s51, s49
  s_xor_b32 s40, s50, 0
  s_mul_i32 s52, s40, 28672
  s_add_u32 s52, s52, s51
  s_xor_b32 s40, s50, 1
  s_mul_i32 s53, s40, 28672
  s_add_u32 s53, s53, s51
  s_xor_b32 s40, s50, 2
  s_mul_i32 s54, s40, 28672
  s_add_u32 s54, s54, s51
  s_xor_b32 s40, s50, 3
  s_mul_i32 s55, s40, 28672
  s_add_u32 s55, s55, s51
  v_lshrrev_b32 v10, 3, v1
  v_and_b32 v11, 7, v1
  v_bfe_u32 v8, v1, 4, 1
  v_lshlrev_b32 v8, 2, v8
  v_xor_b32 v11, v11, v8
  v_mul_u32_u24 v8, 896, v10
  v_lshl_add_u32 v8, v11, 4, v8
  v_add_u32 v9, 6144, v8
  s_mov_b32 s36, s12
  s_mov_b32 s37, s13
  s_mov_b32 s38, 0x188000
  s_mov_b32 s39, 0x00020000
  s_mul_i32 s44, s3, 28672
  s_lshl_b32 s45, s96, 7
  s_add_u32 s44, s44, s45
  s_sub_u32 s46, 1, s95
  s_mul_i32 s46, s46, 114688
  s_add_u32 s46, s46, s44
  s_lshl_b32 s48, s3, 13
  s_add_u32 s48, s48, 65536
  s_waitcnt lgkmcnt(0)
  s_barrier
  s_add_u32 s40, s48, 32768
  s_mov_b32 m0, s40
  s_add_u32 s41, s46, 0
  buffer_load_dwordx4 v8, s[36:39], s41 offen lds
  buffer_load_dwordx4 v9, s[36:39], s41 offen offset:1024 lds
  s_add_u32 s40, s48, 34816
  s_mov_b32 m0, s40
  s_add_u32 s41, s46, 14336
  buffer_load_dwordx4 v8, s[36:39], s41 offen lds
  buffer_load_dwordx4 v9, s[36:39], s41 offen offset:1024 lds
  s_add_u32 s40, s48, 36864
  s_mov_b32 m0, s40
  s_add_u32 s41, s46, 229376
  buffer_load_dwordx4 v8, s[36:39], s41 offen lds
  buffer_load_dwordx4 v9, s[36:39], s41 offen offset:1024 lds
  s_add_u32 s40, s48, 38912
  s_mov_b32 m0, s40
  s_add_u32 s41, s46, 243712
  buffer_load_dwordx4 v8, s[36:39], s41 offen lds
  buffer_load_dwordx4 v9, s[36:39], s41 offen offset:1024 lds
  s_barrier
  s_add_u32 s40, s49, 0
  s_mov_b32 m0, s40
  s_add_u32 s41, s53, 0
  buffer_load_dwordx4 v4, s[16:19], s41 offen sc1 lds
  s_add_u32 s40, s49, 4096
  s_mov_b32 m0, s40
  s_add_u32 s41, s53, 4096
  buffer_load_dwordx4 v4, s[16:19], s41 offen sc1 lds
  s_add_u32 s40, s49, 8192
  s_mov_b32 m0, s40
  s_add_u32 s41, s53, 8192
  buffer_load_dwordx4 v4, s[16:19], s41 offen sc1 lds
  s_add_u32 s40, s49, 12288
  s_mov_b32 m0, s40
  s_add_u32 s41, s53, 12288
  buffer_load_dwordx4 v4, s[16:19], s41 offen sc1 lds
  s_add_u32 s40, s49, 16384
  s_mov_b32 m0, s40
  s_add_u32 s41, s53, 16384
  buffer_load_dwordx4 v4, s[16:19], s41 offen sc1 lds
  s_add_u32 s40, s49, 20480
  s_mov_b32 m0, s40
  s_add_u32 s41, s53, 20480
  buffer_load_dwordx4 v4, s[16:19], s41 offen sc1 lds
  s_add_u32 s40, s49, 24576
  s_mov_b32 m0, s40
  s_add_u32 s41, s53, 24576
  buffer_load_dwordx4 v4, s[16:19], s41 offen sc1 lds
  s_barrier
  s_barrier
  s_add_u32 s40, s49, 28672
  s_mov_b32 m0, s40
  s_add_u32 s41, s54, 0
  buffer_load_dwordx4 v4, s[16:19], s41 offen sc1 lds
  s_add_u32 s40, s49, 32768
  s_mov_b32 m0, s40
  s_add_u32 s41, s54, 4096
  buffer_load_dwordx4 v4, s[16:19], s41 offen sc1 lds
  s_add_u32 s40, s49, 36864
  s_mov_b32 m0, s40
  s_add_u32 s41, s54, 8192
  buffer_load_dwordx4 v4, s[16:19], s41 offen sc1 lds
  s_add_u32 s40, s49, 40960
  s_mov_b32 m0, s40
  s_add_u32 s41, s54, 12288
  buffer_load_dwordx4 v4, s[16:19], s41 offen sc1 lds
  s_add_u32 s40, s49, 45056
  s_mov_b32 m0, s40
  s_add_u32 s41, s54, 16384
  buffer_load_dwordx4 v4, s[16:19], s41 offen sc1 lds
  s_add_u32 s40, s49, 49152
  s_mov_b32 m0, s40
  s_add_u32 s41, s54, 20480
  buffer_load_dwordx4 v4, s[16:19], s41 offen sc1 lds
  s_add_u32 s40, s49, 53248
  s_mov_b32 m0, s40
  s_add_u32 s41, s54, 24576
  buffer_load_dwordx4 v4, s[16:19], s41 offen sc1 lds
  v_and_b32 v10, 7, v1
  v_min_u32 v10, 6, v10
  v_lshlrev_b32 v10, 5, v10
  s_lshl_b32 s40, s95, 4
  s_lshl_b32 s41, s3, 2
  s_add_u32 s40, s40, s41
  v_add_u32 v10, s40, v10
  v_xor_b32 v11, 16, v10
  s_lshl_b32 s40, s94, 18
  s_add_u32 s40, s40, 0x200000
  s_add_u32 s41, s40, 114688
  s_lshl_b32 s42, s94, 17
  s_mul_i32 s43, s94, 114688
  s_add_u32 s43, s43, 0x600000
  s_cmp_eq_u32 s95, 0
  s_cselect_b32 s56, s40, s42
  s_cselect_b32 s58, s41, s43
  s_lshl_b32 s41, s3, 11
  s_add_u32 s56, s56, s41
  s_add_u32 s58, s58, s41
  s_lshl_b32 s41, s95, 13
  s_xor_b32 s42, s41, 8192
  s_add_u32 s57, s56, s42
  s_add_u32 s56, s56, s41
  s_add_u32 s59, s58, s42
  s_add_u32 s58, s58, s41
  v_add_u32 v12, s48, v5
  v_add_u32 v13, s48, v6
  v_mul_u32_u24 v7, 896, v2
  v_lshl_add_u32 v7, v3, 4, v7
  s_waitcnt vmcnt(7)
  s_barrier
  s_add_u32 s40, s49, 131072
  s_mov_b32 m0, s40
  s_add_u32 s41, s55, 0
  buffer_load_dwordx4 v4, s[16:19], s41 offen sc1 lds
  s_add_u32 s40, s49, 135168
  s_mov_b32 m0, s40
  s_add_u32 s41, s55, 4096
  buffer_load_dwordx4 v4, s[16:19], s41 offen sc1 lds
  s_add_u32 s40, s49, 139264
  s_mov_b32 m0, s40
  s_add_u32 s41, s55, 8192
  buffer_load_dwordx4 v4, s[16:19], s41 offen sc1 lds
  s_add_u32 s40, s49, 143360
  s_mov_b32 m0, s40
  s_add_u32 s41, s55, 12288
  buffer_load_dwordx4 v4, s[16:19], s41 offen sc1 lds
  s_add_u32 s40, s49, 147456
  s_mov_b32 m0, s40
  s_add_u32 s41, s55, 16384
  buffer_load_dwordx4 v4, s[16:19], s41 offen sc1 lds
  s_add_u32 s40, s49, 151552
  s_mov_b32 m0, s40
  s_add_u32 s41, s55, 20480
  buffer_load_dwordx4 v4, s[16:19], s41 offen sc1 lds
  s_add_u32 s40, s49, 155648
  s_mov_b32 m0, s40
  s_add_u32 s41, s55, 24576
  buffer_load_dwordx4 v4, s[16:19], s41 offen sc1 lds
  s_lshl_b32 s62, s3, 13
  s_add_u32 s63, s62, 4096
  s_cmp_eq_u32 s3, 3
  s_cselect_b32 s63, 57344, s63
  v_add_u32 v0, s62, v5
  v_add_u32 v1, s62, v6
  v_add_u32 v2, s63, v5
  v_add_u32 v3, s63, v6
  s_barrier
  s_add_u32 s40, s48, 0
  s_mov_b32 m0, s40
  s_add_u32 s41, s46, 458752
  buffer_load_dwordx4 v8, s[36:39], s41 offen lds
  buffer_load_dwordx4 v9, s[36:39], s41 offen offset:1024 lds
  s_add_u32 s40, s48, 2048
  s_mov_b32 m0, s40
  s_add_u32 s41, s46, 473088
  buffer_load_dwordx4 v8, s[36:39], s41 offen lds
  buffer_load_dwordx4 v9, s[36:39], s41 offen offset:1024 lds
  s_add_u32 s40, s48, 4096
  s_mov_b32 m0, s40
  s_add_u32 s41, s46, 688128
  buffer_load_dwordx4 v8, s[36:39], s41 offen lds
  buffer_load_dwordx4 v9, s[36:39], s41 offen offset:1024 lds
  s_add_u32 s40, s48, 6144
  s_mov_b32 m0, s40
  s_add_u32 s41, s46, 702464
  buffer_load_dwordx4 v8, s[36:39], s41 offen lds
  buffer_load_dwordx4 v9, s[36:39], s41 offen offset:1024 lds
  s_waitcnt vmcnt(8)
  s_barrier
  s_barrier
  s_add_u32 s40, s62, 0
  s_mov_b32 m0, s40
  s_add_u32 s41, s46, 917504
  buffer_load_dwordx4 v8, s[36:39], s41 offen lds
  buffer_load_dwordx4 v9, s[36:39], s41 offen offset:1024 lds
  s_add_u32 s40, s62, 2048
  s_mov_b32 m0, s40
  s_add_u32 s41, s46, 931840
  buffer_load_dwordx4 v8, s[36:39], s41 offen lds
  buffer_load_dwordx4 v9, s[36:39], s41 offen offset:1024 lds
  s_add_u32 s40, s63, 0
  s_mov_b32 m0, s40
  s_add_u32 s41, s46, 1146880
  buffer_load_dwordx4 v8, s[36:39], s41 offen lds
  buffer_load_dwordx4 v9, s[36:39], s41 offen offset:1024 lds
  s_add_u32 s40, s63, 2048
  s_mov_b32 m0, s40
  s_add_u32 s41, s46, 1161216
  buffer_load_dwordx4 v8, s[36:39], s41 offen lds
  buffer_load_dwordx4 v9, s[36:39], s41 offen offset:1024 lds
L_poll_37:
  buffer_load_dword v14, v10, s[20:23], s98 offen sc1
  s_waitcnt vmcnt(0)
  v_and_b32 v15, 0xff, v14
  v_cmp_le_u32 vcc, 2, v15
  s_cmp_eq_u64 vcc, exec
  s_cbranch_scc1 L_pd_38
  s_sleep 1
  s_sub_u32 s100, s100, 1
  s_cbranch_scc0 L_poll_37
  s_mov_b32 s100, 0
L_pd_38:
  s_cmp_eq_u32 s99, 0
  s_cbranch_scc1 L_aq_39
  buffer_inv sc1
  s_waitcnt vmcnt(0)
L_aq_39:
  s_add_u32 s40, s56, 0
  buffer_load_dwordx4 v[192:195], v4, s[20:23], s40 offen offset:0 sc1
  buffer_load_dwordx4 v[196:199], v4, s[20:23], s40 offen offset:1024 sc1
  s_add_u32 s40, s58, 16384
  buffer_load_dwordx4 v[200:203], v4, s[20:23], s40 offen offset:0 sc1
  buffer_load_dwordx4 v[204:207], v4, s[20:23], s40 offen offset:1024 sc1
  buffer_load_dword v14, v10, s[20:23], s98 offen sc1
  s_add_u32 s40, s56, 32768
  buffer_load_dwordx4 v[208:211], v4, s[20:23], s40 offen offset:0 sc1
  buffer_load_dwordx4 v[212:215], v4, s[20:23], s40 offen offset:1024 sc1
  s_add_u32 s40, s58, 49152
  buffer_load_dwordx4 v[216:219], v4, s[20:23], s40 offen offset:0 sc1
  buffer_load_dwordx4 v[220:223], v4, s[20:23], s40 offen offset:1024 sc1
  s_add_u32 s40, s56, 65536
  buffer_load_dwordx4 v[224:227], v4, s[20:23], s40 offen offset:0 sc1
  buffer_load_dwordx4 v[228:231], v4, s[20:23], s40 offen offset:1024 sc1
  s_add_u32 s40, s58, 81920
  buffer_load_dwordx4 v[232:235], v4, s[20:23], s40 offen offset:0 sc1
  buffer_load_dwordx4 v[236:239], v4, s[20:23], s40 offen offset:1024 sc1
  s_add_u32 s40, s56, 98304
  buffer_load_dwordx4 v[240:243], v4, s[20:23], s40 offen offset:0 sc1
  buffer_load_dwordx4 v[244:247], v4, s[20:23], s40 offen offset:1024 sc1
  s_waitcnt vmcnt(14)
  v_mfma_f32_32x32x16_bf16 v[128:143], v[16:19], v[192:195], 0
  v_mfma_f32_32x32x16_bf16 v[144:159], v[20:23], v[192:195], 0
  s_waitcnt vmcnt(13)
  v_mfma_f32_32x32x16_bf16 v[128:143], v[24:27], v[196:199], v[128:143]
  v_mfma_f32_32x32x16_bf16 v[144:159], v[28:31], v[196:199], v[144:159]
  s_waitcnt vmcnt(12)
  v_mfma_f32_32x32x16_bf16 v[160:175], v[32:35], v[200:203], 0
  v_mfma_f32_32x32x16_bf16 v[176:191], v[36:39], v[200:203], 0
  s_waitcnt vmcnt(11)
  v_mfma_f32_32x32x16_bf16 v[160:175], v[40:43], v[204:207], v[160:175]
  v_mfma_f32_32x32x16_bf16 v[176:191], v[44:47], v[204:207], v[176:191]
  buffer_load_dword v6, v10, s[20:23], s98 offen sc1
  s_waitcnt vmcnt(11)
  v_and_b32 v15, 0xff, v14
  v_cmp_le_u32 vcc, 3, v15
  s_cmp_eq_u64 vcc, exec
  s_cbranch_scc0 L_qm_40
  s_cmp_eq_u32 s99, 0
  s_cbranch_scc1 L_aq_43
  buffer_inv sc1
  s_waitcnt vmcnt(0)
L_aq_43:
  s_add_u32 s40, s58, 0
  buffer_load_dwordx4 v[192:195], v4, s[20:23], s40 offen offset:0 sc1
  buffer_load_dwordx4 v[196:199], v4, s[20:23], s40 offen offset:1024 sc1
  s_add_u32 s40, s56, 16384
  buffer_load_dwordx4 v[200:203], v4, s[20:23], s40 offen offset:0 sc1
  buffer_load_dwordx4 v[204:207], v4, s[20:23], s40 offen offset:1024 sc1
  s_waitcnt vmcnt(14)
  v_mfma_f32_32x32x16_bf16 v[128:143], v[48:51], v[208:211], v[128:143]
  v_mfma_f32_32x32x16_bf16 v[144:159], v[52:55], v[208:211], v[144:159]
  s_waitcnt vmcnt(13)
  v_mfma_f32_32x32x16_bf16 v[128:143], v[56:59], v[212:215], v[128:143]
  v_mfma_f32_32x32x16_bf16 v[144:159], v[60:63], v[212:215], v[144:159]
  buffer_load_dword v14, v11, s[20:23], s98 offen sc1
  s_add_u32 s40, s58, 32768
  buffer_load_dwordx4 v[208:211], v4, s[20:23], s40 offen offset:0 sc1
  buffer_load_dwordx4 v[212:215], v4, s[20:23], s40 offen offset:1024 sc1
  s_waitcnt vmcnt(15)
  v_mfma_f32_32x32x16_bf16 v[160:175], v[64:67], v[216:219], v[160:175]
  v_mfma_f32_32x32x16_bf16 v[176:191], v[68:71], v[216:219], v[176:191]
  s_waitcnt vmcnt(14)
  v_mfma_f32_32x32x16_bf16 v[160:175], v[72:75], v[220:223], v[160:175]
  v_mfma_f32_32x32x16_bf16 v[176:191], v[76:79], v[220:223], v[176:191]
  s_add_u32 s40, s56, 49152
  buffer_load_dwordx4 v[216:219], v4, s[20:23], s40 offen offset:0 sc1
  buffer_load_dwordx4 v[220:223], v4, s[20:23], s40 offen offset:1024 sc1
  s_waitcnt vmcnt(15)
  v_mfma_f32_32x32x16_bf16 v[128:143], v[80:83], v[224:227], v[128:143]
  v_mfma_f32_32x32x16_bf16 v[144:159], v[84:87], v[224:227], v[144:159]
  s_waitcnt vmcnt(14)
  v_mfma_f32_32x32x16_bf16 v[128:143], v[88:91], v[228:231], v[128:143]
  v_mfma_f32_32x32x16_bf16 v[144:159], v[92:95], v[228:231], v[144:159]
  s_add_u32 s40, s58, 65536
  buffer_load_dwordx4 v[224:227], v4, s[20:23], s40 offen offset:0 sc1
  buffer_load_dwordx4 v[228:231], v4, s[20:23], s40 offen offset:1024 sc1
  s_waitcnt vmcnt(15)
  v_mfma_f32_32x32x16_bf16 v[160:175], v[96:99], v[232:235], v[160:175]
  v_mfma_f32_32x32x16_bf16 v[176:191], v[100:103], v[232:235], v[176:191]
  s_waitcnt vmcnt(14)
  v_mfma_f32_32x32x16_bf16 v[160:175], v[104:107], v[236:239], v[160:175]
  v_mfma_f32_32x32x16_bf16 v[176:191], v[108:111], v[236:239], v[176:191]
  s_add_u32 s40, s56, 81920
  buffer_load_dwordx4 v[232:235], v4, s[20:23], s40 offen offset:0 sc1
  buffer_load_dwordx4 v[236:239], v4, s[20:23], s40 offen offset:1024 sc1
  s_waitcnt vmcnt(15)
  v_mfma_f32_32x32x16_bf16 v[128:143], v[112:115], v[240:243], v[128:143]
  v_mfma_f32_32x32x16_bf16 v[144:159], v[116:119], v[240:243], v[144:159]
  s_waitcnt vmcnt(14)
  v_mfma_f32_32x32x16_bf16 v[128:143], v[120:123], v[244:247], v[128:143]
  v_mfma_f32_32x32x16_bf16 v[144:159], v[124:127], v[244:247], v[144:159]
  s_add_u32 s40, s58, 98304
  buffer_load_dwordx4 v[240:243], v4, s[20:23], s40 offen offset:0 sc1
  buffer_load_dwordx4 v[244:247], v4, s[20:23], s40 offen offset:1024 sc1
  s_branch L_qj_42
L_qm_40:
  s_waitcnt vmcnt(10)
  v_mfma_f32_32x32x16_bf16 v[128:143], v[48:51], v[208:211], v[128:143]
  v_mfma_f32_32x32x16_bf16 v[144:159], v[52:55], v[208:211], v[144:159]
  s_waitcnt vmcnt(9)
  v_mfma_f32_32x32x16_bf16 v[128:143], v[56:59], v[212:215], v[128:143]
  v_mfma_f32_32x32x16_bf16 v[144:159], v[60:63], v[212:215], v[144:159]
  s_waitcnt vmcnt(8)
  v_mfma_f32_32x32x16_bf16 v[160:175], v[64:67], v[216:219], v[160:175]
  v_mfma_f32_32x32x16_bf16 v[176:191], v[68:71], v[216:219], v[176:191]
  s_waitcnt vmcnt(7)
  v_mfma_f32_32x32x16_bf16 v[160:175], v[72:75], v[220:223], v[160:175]
  v_mfma_f32_32x32x16_bf16 v[176:191], v[76:79], v[220:223], v[176:191]
  s_waitcnt vmcnt(0)
  v_and_b32 v15, 0xff, v6
  v_cmp_le_u32 vcc, 3, v15
  s_cmp_eq_u64 vcc, exec
  s_cbranch_scc0 L_qs_41
  s_cmp_eq_u32 s99, 0
  s_cbranch_scc1 L_aq_44
  buffer_inv sc1
  s_waitcnt vmcnt(0)
L_aq_44:
  s_add_u32 s40, s58, 0
  buffer_load_dwordx4 v[192:195], v4, s[20:23], s40 offen offset:0 sc1
  buffer_load_dwordx4 v[196:199], v4, s[20:23], s40 offen offset:1024 sc1
  s_add_u32 s40, s56, 16384
  buffer_load_dwordx4 v[200:203], v4, s[20:23], s40 offen offset:0 sc1
  buffer_load_dwordx4 v[204:207], v4, s[20:23], s40 offen offset:1024 sc1
  buffer_load_dword v14, v11, s[20:23], s98 offen sc1
  s_add_u32 s40, s58, 32768
  buffer_load_dwordx4 v[208:211], v4, s[20:23], s40 offen offset:0 sc1
  buffer_load_dwordx4 v[212:215], v4, s[20:23], s40 offen offset:1024 sc1
  s_add_u32 s40, s56, 49152
  buffer_load_dwordx4 v[216:219], v4, s[20:23], s40 offen offset:0 sc1
  buffer_load_dwordx4 v[220:223], v4, s[20:23], s40 offen offset:1024 sc1
  v_mfma_f32_32x32x16_bf16 v[128:143], v[80:83], v[224:227], v[128:143]
  v_mfma_f32_32x32x16_bf16 v[144:159], v[84:87], v[224:227], v[144:159]
  v_mfma_f32_32x32x16_bf16 v[128:143], v[88:91], v[228:231], v[128:143]
  v_mfma_f32_32x32x16_bf16 v[144:159], v[92:95], v[228:231], v[144:159]
  s_add_u32 s40, s58, 65536
  buffer_load_dwordx4 v[224:227], v4, s[20:23], s40 offen offset:0 sc1
  buffer_load_dwordx4 v[228:231], v4, s[20:23], s40 offen offset:1024 sc1
  v_mfma_f32_32x32x16_bf16 v[160:175], v[96:99], v[232:235], v[160:175]
  v_mfma_f32_32x32x16_bf16 v[176:191], v[100:103], v[232:235], v[176:191]
  v_mfma_f32_32x32x16_bf16 v[160:175], v[104:107], v[236:239], v[160:175]
  v_mfma_f32_32x32x16_bf16 v[176:191], v[108:111], v[236:239], v[176:191]
  s_add_u32 s40, s56, 81920
  buffer_load_dwordx4 v[232:235], v4, s[20:23], s40 offen offset:0 sc1
  buffer_load_dwordx4 v[236:239], v4, s[20:23], s40 offen offset:1024 sc1
  v_mfma_f32_32x32x16_bf16 v[128:143], v[112:115], v[240:243], v[128:143]
  v_mfma_f32_32x32x16_bf16 v[144:159], v[116:119], v[240:243], v[144:159]
  v_mfma_f32_32x32x16_bf16 v[128:143], v[120:123], v[244:247], v[128:143]
  v_mfma_f32_32x32x16_bf16 v[144:159], v[124:127], v[244:247], v[144:159]
  s_add_u32 s40, s58, 98304
  buffer_load_dwordx4 v[240:243], v4, s[20:23], s40 offen offset:0 sc1
  buffer_load_dwordx4 v[244:247], v4, s[20:23], s40 offen offset:1024 sc1
  s_branch L_qj_42
L_qs_41:
  v_mfma_f32_32x32x16_bf16 v[128:143], v[80:83], v[224:227], v[128:143]
  v_mfma_f32_32x32x16_bf16 v[144:159], v[84:87], v[224:227], v[144:159]
  v_mfma_f32_32x32x16_bf16 v[128:143], v[88:91], v[228:231], v[128:143]
  v_mfma_f32_32x32x16_bf16 v[144:159], v[92:95], v[228:231], v[144:159]
  v_mfma_f32_32x32x16_bf16 v[160:175], v[96:99], v[232:235], v[160:175]
  v_mfma_f32_32x32x16_bf16 v[176:191], v[100:103], v[232:235], v[176:191]
  v_mfma_f32_32x32x16_bf16 v[160:175], v[104:107], v[236:239], v[160:175]
  v_mfma_f32_32x32x16_bf16 v[176:191], v[108:111], v[236:239], v[176:191]
  v_mfma_f32_32x32x16_bf16 v[128:143], v[112:115], v[240:243], v[128:143]
  v_mfma_f32_32x32x16_bf16 v[144:159], v[116:119], v[240:243], v[144:159]
  v_mfma_f32_32x32x16_bf16 v[128:143], v[120:123], v[244:247], v[128:143]
  v_mfma_f32_32x32x16_bf16 v[144:159], v[124:127], v[244:247], v[144:159]
L_poll_45:
  buffer_load_dword v14, v10, s[20:23], s98 offen sc1
  s_waitcnt vmcnt(0)
  v_and_b32 v15, 0xff, v14
  v_cmp_le_u32 vcc, 3, v15
  s_cmp_eq_u64 vcc, exec
  s_cbranch_scc1 L_pd_46
  s_sleep 1
  s_sub_u32 s100, s100, 1
  s_cbranch_scc0 L_poll_45
  s_mov_b32 s100, 0
L_pd_46:
  s_cmp_eq_u32 s99, 0
  s_cbranch_scc1 L_aq_47
  buffer_inv sc1
  s_waitcnt vmcnt(0)
L_aq_47:
  s_add_u32 s40, s58, 0
  buffer_load_dwordx4 v[192:195], v4, s[20:23], s40 offen offset:0 sc1
  buffer_load_dwordx4 v[196:199], v4, s[20:23], s40 offen offset:1024 sc1
  s_add_u32 s40, s56, 16384
  buffer_load_dwordx4 v[200:203], v4, s[20:23], s40 offen offset:0 sc1
  buffer_load_dwordx4 v[204:207], v4, s[20:23], s40 offen offset:1024 sc1
  buffer_load_dword v14, v11, s[20:23], s98 offen sc1
  s_add_u32 s40, s58, 32768
  buffer_load_dwordx4 v[208:211], v4, s[20:23], s40 offen offset:0 sc1
  buffer_load_dwordx4 v[212:215], v4, s[20:23], s40 offen offset:1024 sc1
  s_add_u32 s40, s56, 49152
  buffer_load_dwordx4 v[216:219], v4, s[20:23], s40 offen offset:0 sc1
  buffer_load_dwordx4 v[220:223], v4, s[20:23], s40 offen offset:1024 sc1
  s_add_u32 s40, s58, 65536
  buffer_load_dwordx4 v[224:227], v4, s[20:23], s40 offen offset:0 sc1
  buffer_load_dwordx4 v[228:231], v4, s[20:23], s40 offen offset:1024 sc1
  s_add_u32 s40, s56, 81920
  buffer_load_dwordx4 v[232:235], v4, s[20:23], s40 offen offset:0 sc1
  buffer_load_dwordx4 v[236:239], v4, s[20:23], s40 offen offset:1024 sc1
  s_add_u32 s40, s58, 98304
  buffer_load_dwordx4 v[240:243], v4, s[20:23], s40 offen offset:0 sc1
  buffer_load_dwordx4 v[244:247], v4, s[20:23], s40 offen offset:1024 sc1
L_qj_42:
  s_waitcnt vmcnt(14)
  v_mfma_f32_32x32x16_bf16 v[160:175], v[16:19], v[192:195], v[160:175]
  v_mfma_f32_32x32x16_bf16 v[176:191], v[20:23], v[192:195], v[176:191]
  s_waitcnt vmcnt(13)
  v_mfma_f32_32x32x16_bf16 v[160:175], v[24:27], v[196:199], v[160:175]
  v_mfma_f32_32x32x16_bf16 v[176:191], v[28:31], v[196:199], v[176:191]
  s_waitcnt vmcnt(12)
  v_mfma_f32_32x32x16_bf16 v[128:143], v[32:35], v[200:203], v[128:143]
  v_mfma_f32_32x32x16_bf16 v[144:159], v[36:39], v[200:203], v[144:159]
  s_waitcnt vmcnt(11)
  v_mfma_f32_32x32x16_bf16 v[128:143], v[40:43], v[204:207], v[128:143]
  v_mfma_f32_32x32x16_bf16 v[144:159], v[44:47], v[204:207], v[144:159]
  ds_read_b64_tr_b16 v[16:17], v12 offset:32768
  ds_read_b64_tr_b16 v[18:19], v12 offset:33792
  ds_read_b64_tr_b16 v[20:21], v13 offset:32768
  ds_read_b64_tr_b16 v[22:23], v13 offset:33792
  ds_read_b64_tr_b16 v[24:25], v12 offset:34816
  ds_read_b64_tr_b16 v[26:27], v12 offset:35840
  ds_read_b64_tr_b16 v[28:29], v13 offset:34816
  ds_read_b64_tr_b16 v[30:31], v13 offset:35840
  buffer_load_dword v6, v11, s[20:23], s98 offen sc1
  s_waitcnt vmcnt(11)
  v_and_b32 v15, 0xff, v14
  v_cmp_le_u32 vcc, 4, v15
  s_cmp_eq_u64 vcc, exec
  s_cbranch_scc0 L_qm_48
  s_cmp_eq_u32 s99, 0
  s_cbranch_scc1 L_aq_51
  buffer_inv sc1
  s_waitcnt vmcnt(0)
L_aq_51:
  s_add_u32 s40, s57, 0
  buffer_load_dwordx4 v[192:195], v4, s[20:23], s40 offen offset:0 sc1
  buffer_load_dwordx4 v[196:199], v4, s[20:23], s40 offen offset:1024 sc1
  s_add_u32 s40, s59, 16384
  buffer_load_dwordx4 v[200:203], v4, s[20:23], s40 offen offset:0 sc1
  buffer_load_dwordx4 v[204:207], v4, s[20:23], s40 offen offset:1024 sc1
  s_waitcnt vmcnt(14)
  v_mfma_f32_32x32x16_bf16 v[160:175], v[48:51], v[208:211], v[160:175]
  v_mfma_f32_32x32x16_bf16 v[176:191], v[52:55], v[208:211], v[176:191]
  s_waitcnt vmcnt(13)
  v_mfma_f32_32x32x16_bf16 v[160:175], v[56:59], v[212:215], v[160:175]
  v_mfma_f32_32x32x16_bf16 v[176:191], v[60:63], v[212:215], v[176:191]
  ds_read_b64_tr_b16 v[32:33], v12 offset:36864
  ds_read_b64_tr_b16 v[34:35], v12 offset:37888
  ds_read_b64_tr_b16 v[36:37], v13 offset:36864
  ds_read_b64_tr_b16 v[38:39], v13 offset:37888
  ds_read_b64_tr_b16 v[40:41], v12 offset:38912
  ds_read_b64_tr_b16 v[42:43], v12 offset:39936
  ds_read_b64_tr_b16 v[44:45], v13 offset:38912
  ds_read_b64_tr_b16 v[46:47], v13 offset:39936
  buffer_load_dword v14, v11, s[20:23], s98 offen sc1
  s_add_u32 s40, s57, 32768
  buffer_load_dwordx4 v[208:211], v4, s[20:23], s40 offen offset:0 sc1
  buffer_load_dwordx4 v[212:215], v4, s[20:23], s40 offen offset:1024 sc1
  s_waitcnt vmcnt(15)
  v_mfma_f32_32x32x16_bf16 v[128:143], v[64:67], v[216:219], v[128:143]
  v_mfma_f32_32x32x16_bf16 v[144:159], v[68:71], v[216:219], v[144:159]
  s_waitcnt vmcnt(14)
  v_mfma_f32_32x32x16_bf16 v[128:143], v[72:75], v[220:223], v[128:143]
  v_mfma_f32_32x32x16_bf16 v[144:159], v[76:79], v[220:223], v[144:159]
  ds_read_b64_tr_b16 v[48:49], v12 offset:0
  ds_read_b64_tr_b16 v[50:51], v12 offset:1024
  ds_read_b64_tr_b16 v[52:53], v13 offset:0
  ds_read_b64_tr_b16 v[54:55], v13 offset:1024
  ds_read_b64_tr_b16 v[56:57], v12 offset:2048
  ds_read_b64_tr_b16 v[58:59], v12 offset:3072
  ds_read_b64_tr_b16 v[60:61], v13 offset:2048
  ds_read_b64_tr_b16 v[62:63], v13 offset:3072
  s_add_u32 s40, s59, 49152
  buffer_load_dwordx4 v[216:219], v4, s[20:23], s40 offen offset:0 sc1
  buffer_load_dwordx4 v[220:223], v4, s[20:23], s40 offen offset:1024 sc1
  s_waitcnt vmcnt(15)
  v_mfma_f32_32x32x16_bf16 v[160:175], v[80:83], v[224:227], v[160:175]
  v_mfma_f32_32x32x16_bf16 v[176:191], v[84:87], v[224:227], v[176:191]
  s_waitcnt vmcnt(14)
  v_mfma_f32_32x32x16_bf16 v[160:175], v[88:91], v[228:231], v[160:175]
  v_mfma_f32_32x32x16_bf16 v[176:191], v[92:95], v[228:231], v[176:191]
  ds_read_b64_tr_b16 v[64:65], v12 offset:4096
  ds_read_b64_tr_b16 v[66:67], v12 offset:5120
  ds_read_b64_tr_b16 v[68:69], v13 offset:4096
  ds_read_b64_tr_b16 v[70:71], v13 offset:5120
  ds_read_b64_tr_b16 v[72:73], v12 offset:6144
  ds_read_b64_tr_b16 v[74:75], v12 offset:7168
  ds_read_b64_tr_b16 v[76:77], v13 offset:6144
  ds_read_b64_tr_b16 v[78:79], v13 offset:7168
  s_waitcnt lgkmcnt(8)
  s_add_u32 s40, s48, 0
  s_mov_b32 m0, s40
  s_add_u32 s41, s46, 1376256
  buffer_load_dwordx4 v8, s[36:39], s41 offen offset:0 lds
  buffer_load_dwordx4 v9, s[36:39], s41 offen offset:1024 lds
  s_add_u32 s40, s48, 2048
  s_mov_b32 m0, s40
  s_add_u32 s41, s46, 1390592
  buffer_load_dwordx4 v8, s[36:39], s41 offen offset:0 lds
  buffer_load_dwordx4 v9, s[36:39], s41 offen offset:1024 lds
  s_add_u32 s40, s57, 65536
  buffer_load_dwordx4 v[224:227], v4, s[20:23], s40 offen offset:0 sc1
  buffer_load_dwordx4 v[228:231], v4, s[20:23], s40 offen offset:1024 sc1
  s_waitcnt vmcnt(19)
  v_mfma_f32_32x32x16_bf16 v[128:143], v[96:99], v[232:235], v[128:143]
  v_mfma_f32_32x32x16_bf16 v[144:159], v[100:103], v[232:235], v[144:159]
  s_waitcnt vmcnt(18)
  v_mfma_f32_32x32x16_bf16 v[128:143], v[104:107], v[236:239], v[128:143]
  v_mfma_f32_32x32x16_bf16 v[144:159], v[108:111], v[236:239], v[144:159]
  ds_read_b64_tr_b16 v[80:81], v0 offset:0
  ds_read_b64_tr_b16 v[82:83], v0 offset:1024
  ds_read_b64_tr_b16 v[84:85], v1 offset:0
  ds_read_b64_tr_b16 v[86:87], v1 offset:1024
  ds_read_b64_tr_b16 v[88:89], v0 offset:2048
  ds_read_b64_tr_b16 v[90:91], v0 offset:3072
  ds_read_b64_tr_b16 v[92:93], v1 offset:2048
  ds_read_b64_tr_b16 v[94:95], v1 offset:3072
  s_add_u32 s40, s59, 81920
  buffer_load_dwordx4 v[232:235], v4, s[20:23], s40 offen offset:0 sc1
  buffer_load_dwordx4 v[236:239], v4, s[20:23], s40 offen offset:1024 sc1
  s_waitcnt vmcnt(19)
  v_mfma_f32_32x32x16_bf16 v[160:175], v[112:115], v[240:243], v[160:175]
  v_mfma_f32_32x32x16_bf16 v[176:191], v[116:119], v[240:243], v[176:191]
  s_waitcnt vmcnt(18)
  v_mfma_f32_32x32x16_bf16 v[160:175], v[120:123], v[244:247], v[160:175]
  v_mfma_f32_32x32x16_bf16 v[176:191], v[124:127], v[244:247], v[176:191]
  ds_read_b64_tr_b16 v[96:97], v2 offset:0
  ds_read_b64_tr_b16 v[98:99], v2 offset:1024
  ds_read_b64_tr_b16 v[100:101], v3 offset:0
  ds_read_b64_tr_b16 v[102:103], v3 offset:1024
  ds_read_b64_tr_b16 v[104:105], v2 offset:2048
  ds_read_b64_tr_b16 v[106:107], v2 offset:3072
  ds_read_b64_tr_b16 v[108:109], v3 offset:2048
  ds_read_b64_tr_b16 v[110:111], v3 offset:3072
  s_add_u32 s40, s57, 98304
  buffer_load_dwordx4 v[240:243], v4, s[20:23], s40 offen offset:0 sc1
  buffer_load_dwordx4 v[244:247], v4, s[20:23], s40 offen offset:1024 sc1
  s_branch L_qj_50
L_qm_48:
  s_waitcnt vmcnt(10)
  v_mfma_f32_32x32x16_bf16 v[160:175], v[48:51], v[208:211], v[160:175]
  v_mfma_f32_32x32x16_bf16 v[176:191], v[52:55], v[208:211], v[176:191]
  s_waitcnt vmcnt(9)
  v_mfma_f32_32x32x16_bf16 v[160:175], v[56:59], v[212:215], v[160:175]
  v_mfma_f32_32x32x16_bf16 v[176:191], v[60:63], v[212:215], v[176:191]
  ds_read_b64_tr_b16 v[32:33], v12 offset:36864
  ds_read_b64_tr_b16 v[34:35], v12 offset:37888
  ds_read_b64_tr_b16 v[36:37], v13 offset:36864
  ds_read_b64_tr_b16 v[38:39], v13 offset:37888
  ds_read_b64_tr_b16 v[40:41], v12 offset:38912
  ds_read_b64_tr_b16 v[42:43], v12 offset:39936
  ds_read_b64_tr_b16 v[44:45], v13 offset:38912
  ds_read_b64_tr_b16 v[46:47], v13 offset:39936
  s_waitcnt vmcnt(8)
  v_mfma_f32_32x32x16_bf16 v[128:143], v[64:67], v[216:219], v[128:143]
  v_mfma_f32_32x32x16_bf16 v[144:159], v[68:71], v[216:219], v[144:159]
  s_waitcnt vmcnt(7)
  v_mfma_f32_32x32x16_bf16 v[128:143], v[72:75], v[220:223], v[128:143]
  v_mfma_f32_32x32x16_bf16 v[144:159], v[76:79], v[220:223], v[144:159]
  ds_read_b64_tr_b16 v[48:49], v12 offset:0
  ds_read_b64_tr_b16 v[50:51], v12 offset:1024
  ds_read_b64_tr_b16 v[52:53], v13 offset:0
  ds_read_b64_tr_b16 v[54:55], v13 offset:1024
  ds_read_b64_tr_b16 v[56:57], v12 offset:2048
  ds_read_b64_tr_b16 v[58:59], v12 offset:3072
  ds_read_b64_tr_b16 v[60:61], v13 offset:2048
  ds_read_b64_tr_b16 v[62:63], v13 offset:3072
  s_waitcnt vmcnt(0)
  v_and_b32 v15, 0xff, v6
  v_cmp_le_u32 vcc, 4, v15
  s_cmp_eq_u64 vcc, exec
  s_cbranch_scc0 L_qs_49
  s_cmp_eq_u32 s99, 0
  s_cbranch_scc1 L_aq_52
  buffer_inv sc1
  s_waitcnt vmcnt(0)
L_aq_52:
  s_add_u32 s40, s57, 0
  buffer_load_dwordx4 v[192:195], v4, s[20:23], s40 offen offset:0 sc1
  buffer_load_dwordx4 v[196:199], v4, s[20:23], s40 offen offset:1024 sc1
  s_add_u32 s40, s59, 16384
  buffer_load_dwordx4 v[200:203], v4, s[20:23], s40 offen offset:0 sc1
  buffer_load_dwordx4 v[204:207], v4, s[20:23], s40 offen offset:1024 sc1
  buffer_load_dword v14, v11, s[20:23], s98 offen sc1
  s_add_u32 s40, s57, 32768
  buffer_load_dwordx4 v[208:211], v4, s[20:23], s40 offen offset:0 sc1
  buffer_load_dwordx4 v[212:215], v4, s[20:23], s40 offen offset:1024 sc1
  s_add_u32 s40, s59, 49152
  buffer_load_dwordx4 v[216:219], v4, s[20:23], s40 offen offset:0 sc1
  buffer_load_dwordx4 v[220:223], v4, s[20:23], s40 offen offset:1024 sc1
  v_mfma_f32_32x32x16_bf16 v[160:175], v[80:83], v[224:227], v[160:175]
  v_mfma_f32_32x32x16_bf16 v[176:191], v[84:87], v[224:227], v[176:191]
  v_mfma_f32_32x32x16_bf16 v[160:175], v[88:91], v[228:231], v[160:175]
  v_mfma_f32_32x32x16_bf16 v[176:191], v[92:95], v[228:231], v[176:191]
  ds_read_b64_tr_b16 v[64:65], v12 offset:4096
  ds_read_b64_tr_b16 v[66:67], v12 offset:5120
  ds_read_b64_tr_b16 v[68:69], v13 offset:4096
  ds_read_b64_tr_b16 v[70:71], v13 offset:5120
  ds_read_b64_tr_b16 v[72:73], v12 offset:6144
  ds_read_b64_tr_b16 v[74:75], v12 offset:7168
  ds_read_b64_tr_b16 v[76:77], v13 offset:6144
  ds_read_b64_tr_b16 v[78:79], v13 offset:7168
  s_waitcnt lgkmcnt(8)
  s_add_u32 s40, s48, 0
  s_mov_b32 m0, s40
  s_add_u32 s41, s46, 1376256
  buffer_load_dwordx4 v8, s[36:39], s41 offen offset:0 lds
  buffer_load_dwordx4 v9, s[36:39], s41 offen offset:1024 lds
  s_add_u32 s40, s48, 2048
  s_mov_b32 m0, s40
  s_add_u32 s41, s46, 1390592
  buffer_load_dwordx4 v8, s[36:39], s41 offen offset:0 lds
  buffer_load_dwordx4 v9, s[36:39], s41 offen offset:1024 lds
  s_add_u32 s40, s57, 65536
  buffer_load_dwordx4 v[224:227], v4, s[20:23], s40 offen offset:0 sc1
  buffer_load_dwordx4 v[228:231], v4, s[20:23], s40 offen offset:1024 sc1
  v_mfma_f32_32x32x16_bf16 v[128:143], v[96:99], v[232:235], v[128:143]
  v_mfma_f32_32x32x16_bf16 v[144:159], v[100:103], v[232:235], v[144:159]
  v_mfma_f32_32x32x16_bf16 v[128:143], v[104:107], v[236:239], v[128:143]
  v_mfma_f32_32x32x16_bf16 v[144:159], v[108:111], v[236:239], v[144:159]
  ds_read_b64_tr_b16 v[80:81], v0 offset:0
  ds_read_b64_tr_b16 v[82:83], v0 offset:1024
  ds_read_b64_tr_b16 v[84:85], v1 offset:0
  ds_read_b64_tr_b16 v[86:87], v1 offset:1024
  ds_read_b64_tr_b16 v[88:89], v0 offset:2048
  ds_read_b64_tr_b16 v[90:91], v0 offset:3072
  ds_read_b64_tr_b16 v[92:93], v1 offset:2048
  ds_read_b64_tr_b16 v[94:95], v1 offset:3072
  s_add_u32 s40, s59, 81920
  buffer_load_dwordx4 v[232:235], v4, s[20:23], s40 offen offset:0 sc1
  buffer_load_dwordx4 v[236:239], v4, s[20:23], s40 offen offset:1024 sc1
  v_mfma_f32_32x32x16_bf16 v[160:175], v[112:115], v[240:243], v[160:175]
  v_mfma_f32_32x32x16_bf16 v[176:191], v[116:119], v[240:243], v[176:191]
  v_mfma_f32_32x32x16_bf16 v[160:175], v[120:123], v[244:247], v[160:175]
  v_mfma_f32_32x32x16_bf16 v[176:191], v[124:127], v[244:247], v[176:191]
  ds_read_b64_tr_b16 v[96:97], v2 offset:0
  ds_read_b64_tr_b16 v[98:99], v2 offset:1024
  ds_read_b64_tr_b16 v[100:101], v3 offset:0
  ds_read_b64_tr_b16 v[102:103], v3 offset:1024
  ds_read_b64_tr_b16 v[104:105], v2 offset:2048
  ds_read_b64_tr_b16 v[106:107], v2 offset:3072
  ds_read_b64_tr_b16 v[108:109], v3 offset:2048
  ds_read_b64_tr_b16 v[110:111], v3 offset:3072
  s_add_u32 s40, s57, 98304
  buffer_load_dwordx4 v[240:243], v4, s[20:23], s40 offen offset:0 sc1
  buffer_load_dwordx4 v[244:247], v4, s[20:23], s40 offen offset:1024 sc1
  s_branch L_qj_50
L_qs_49:
  v_mfma_f32_32x32x16_bf16 v[160:175], v[80:83], v[224:227], v[160:175]
  v_mfma_f32_32x32x16_bf16 v[176:191], v[84:87], v[224:227], v[176:191]
  v_mfma_f32_32x32x16_bf16 v[160:175], v[88:91], v[228:231], v[160:175]
  v_mfma_f32_32x32x16_bf16 v[176:191], v[92:95], v[228:231], v[176:191]
  ds_read_b64_tr_b16 v[64:65], v12 offset:4096
  ds_read_b64_tr_b16 v[66:67], v12 offset:5120
  ds_read_b64_tr_b16 v[68:69], v13 offset:4096
  ds_read_b64_tr_b16 v[70:71], v13 offset:5120
  ds_read_b64_tr_b16 v[72:73], v12 offset:6144
  ds_read_b64_tr_b16 v[74:75], v12 offset:7168
  ds_read_b64_tr_b16 v[76:77], v13 offset:6144
  ds_read_b64_tr_b16 v[78:79], v13 offset:7168
  v_mfma_f32_32x32x16_bf16 v[128:143], v[96:99], v[232:235], v[128:143]
  v_mfma_f32_32x32x16_bf16 v[144:159], v[100:103], v[232:235], v[144:159]
  v_mfma_f32_32x32x16_bf16 v[128:143], v[104:107], v[236:239], v[128:143]
  v_mfma_f32_32x32x16_bf16 v[144:159], v[108:111], v[236:239], v[144:159]
  ds_read_b64_tr_b16 v[80:81], v0 offset:0
  ds_read_b64_tr_b16 v[82:83], v0 offset:1024
  ds_read_b64_tr_b16 v[84:85], v1 offset:0
  ds_read_b64_tr_b16 v[86:87], v1 offset:1024
  ds_read_b64_tr_b16 v[88:89], v0 offset:2048
  ds_read_b64_tr_b16 v[90:91], v0 offset:3072
  ds_read_b64_tr_b16 v[92:93], v1 offset:2048
  ds_read_b64_tr_b16 v[94:95], v1 offset:3072
  v_mfma_f32_32x32x16_bf16 v[160:175], v[112:115], v[240:243], v[160:175]
  v_mfma_f32_32x32x16_bf16 v[176:191], v[116:119], v[240:243], v[176:191]
  v_mfma_f32_32x32x16_bf16 v[160:175], v[120:123], v[244:247], v[160:175]
  v_mfma_f32_32x32x16_bf16 v[176:191], v[124:127], v[244:247], v[176:191]
  ds_read_b64_tr_b16 v[96:97], v2 offset:0
  ds_read_b64_tr_b16 v[98:99], v2 offset:1024
  ds_read_b64_tr_b16 v[100:101], v3 offset:0
  ds_read_b64_tr_b16 v[102:103], v3 offset:1024
  ds_read_b64_tr_b16 v[104:105], v2 offset:2048
  ds_read_b64_tr_b16 v[106:107], v2 offset:3072
  ds_read_b64_tr_b16 v[108:109], v3 offset:2048
  ds_read_b64_tr_b16 v[110:111], v3 offset:3072
L_poll_53:
  buffer_load_dword v14, v11, s[20:23], s98 offen sc1
  s_waitcnt vmcnt(0)
  v_and_b32 v15, 0xff, v14
  v_cmp_le_u32 vcc, 4, v15
  s_cmp_eq_u64 vcc, exec
  s_cbranch_scc1 L_pd_54
  s_sleep 1
  s_sub_u32 s100, s100, 1
  s_cbranch_scc0 L_poll_53
  s_mov_b32 s100, 0
L_pd_54:
  s_cmp_eq_u32 s99, 0
  s_cbranch_scc1 L_aq_55
  buffer_inv sc1
  s_waitcnt vmcnt(0)
L_aq_55:
  s_add_u32 s40, s57, 0
  buffer_load_dwordx4 v[192:195], v4, s[20:23], s40 offen offset:0 sc1
  buffer_load_dwordx4 v[196:199], v4, s[20:23], s40 offen offset:1024 sc1
  s_add_u32 s40, s59, 16384
  buffer_load_dwordx4 v[200:203], v4, s[20:23], s40 offen offset:0 sc1
  buffer_load_dwordx4 v[204:207], v4, s[20:23], s40 offen offset:1024 sc1
  buffer_load_dword v14, v11, s[20:23], s98 offen sc1
  s_add_u32 s40, s57, 32768
  buffer_load_dwordx4 v[208:211], v4, s[20:23], s40 offen offset:0 sc1
  buffer_load_dwordx4 v[212:215], v4, s[20:23], s40 offen offset:1024 sc1
  s_add_u32 s40, s59, 49152
  buffer_load_dwordx4 v[216:219], v4, s[20:23], s40 offen offset:0 sc1
  buffer_load_dwordx4 v[220:223], v4, s[20:23], s40 offen offset:1024 sc1
  s_waitcnt lgkmcnt(15)
  s_add_u32 s40, s48, 0
  s_mov_b32 m0, s40
  s_add_u32 s41, s46, 1376256
  buffer_load_dwordx4 v8, s[36:39], s41 offen offset:0 lds
  buffer_load_dwordx4 v9, s[36:39], s41 offen offset:1024 lds
  s_add_u32 s40, s48, 2048
  s_mov_b32 m0, s40
  s_add_u32 s41, s46, 1390592
  buffer_load_dwordx4 v8, s[36:39], s41 offen offset:0 lds
  buffer_load_dwordx4 v9, s[36:39], s41 offen offset:1024 lds
  s_add_u32 s40, s57, 65536
  buffer_load_dwordx4 v[224:227], v4, s[20:23], s40 offen offset:0 sc1
  buffer_load_dwordx4 v[228:231], v4, s[20:23], s40 offen offset:1024 sc1
  s_add_u32 s40, s59, 81920
  buffer_load_dwordx4 v[232:235], v4, s[20:23], s40 offen offset:0 sc1
  buffer_load_dwordx4 v[236:239], v4, s[20:23], s40 offen offset:1024 sc1
  s_add_u32 s40, s57, 98304
  buffer_load_dwordx4 v[240:243], v4, s[20:23], s40 offen offset:0 sc1
  buffer_load_dwordx4 v[244:247], v4, s[20:23], s40 offen offset:1024 sc1
L_qj_50:
  s_waitcnt vmcnt(18)
  v_mfma_f32_32x32x16_bf16 v[128:143], v[16:19], v[192:195], v[128:143]
  v_mfma_f32_32x32x16_bf16 v[144:159], v[20:23], v[192:195], v[144:159]
  s_waitcnt vmcnt(17)
  v_mfma_f32_32x32x16_bf16 v[128:143], v[24:27], v[196:199], v[128:143]
  v_mfma_f32_32x32x16_bf16 v[144:159], v[28:31], v[196:199], v[144:159]
  s_waitcnt vmcnt(16)
  v_mfma_f32_32x32x16_bf16 v[160:175], v[32:35], v[200:203], v[160:175]
  v_mfma_f32_32x32x16_bf16 v[176:191], v[36:39], v[200:203], v[176:191]
  s_waitcnt vmcnt(15)
  v_mfma_f32_32x32x16_bf16 v[160:175], v[40:43], v[204:207], v[160:175]
  v_mfma_f32_32x32x16_bf16 v[176:191], v[44:47], v[204:207], v[176:191]
  buffer_load_dword v6, v11, s[20:23], s98 offen sc1
  s_waitcnt vmcnt(15)
  v_and_b32 v15, 0xff, v14
  v_cmp_le_u32 vcc, 5, v15
  s_cmp_eq_u64 vcc, exec
  s_cbranch_scc0 L_qm_56
  s_cmp_eq_u32 s99, 0
  s_cbranch_scc1 L_aq_59
  buffer_inv sc1
  s_waitcnt vmcnt(0)
L_aq_59:
  s_add_u32 s40, s59, 0
  buffer_load_dwordx4 v[192:195], v4, s[20:23], s40 offen offset:0 sc1
  buffer_load_dwordx4 v[196:199], v4, s[20:23], s40 offen offset:1024 sc1
  s_add_u32 s40, s57, 16384
  buffer_load_dwordx4 v[200:203], v4, s[20:23], s40 offen offset:0 sc1
  buffer_load_dwordx4 v[204:207], v4, s[20:23], s40 offen offset:1024 sc1
  s_waitcnt vmcnt(18)
  v_mfma_f32_32x32x16_bf16 v[128:143], v[48:51], v[208:211], v[128:143]
  v_mfma_f32_32x32x16_bf16 v[144:159], v[52:55], v[208:211], v[144:159]
  s_waitcnt vmcnt(17)
  v_mfma_f32_32x32x16_bf16 v[128:143], v[56:59], v[212:215], v[128:143]
  v_mfma_f32_32x32x16_bf16 v[144:159], v[60:63], v[212:215], v[144:159]
  s_waitcnt vmcnt(11)
  ds_read_b64_tr_b16 v[112:113], v12 offset:0
  ds_read_b64_tr_b16 v[114:115], v12 offset:1024
  ds_read_b64_tr_b16 v[116:117], v13 offset:0
  ds_read_b64_tr_b16 v[118:119], v13 offset:1024
  ds_read_b64_tr_b16 v[120:121], v12 offset:2048
  ds_read_b64_tr_b16 v[122:123], v12 offset:3072
  ds_read_b64_tr_b16 v[124:125], v13 offset:2048
  ds_read_b64_tr_b16 v[126:127], v13 offset:3072
  s_add_u32 s40, s59, 32768
  buffer_load_dwordx4 v[208:211], v4, s[20:23], s40 offen offset:0 sc1
  buffer_load_dwordx4 v[212:215], v4, s[20:23], s40 offen offset:1024 sc1
  s_waitcnt lgkmcnt(15)
  v_mfma_f32_32x32x16_bf16 v[160:175], v[64:67], v[216:219], v[160:175]
  v_mfma_f32_32x32x16_bf16 v[176:191], v[68:71], v[216:219], v[176:191]
  v_mfma_f32_32x32x16_bf16 v[160:175], v[72:75], v[220:223], v[160:175]
  v_mfma_f32_32x32x16_bf16 v[176:191], v[76:79], v[220:223], v[176:191]
  s_add_u32 s40, s57, 49152
  buffer_load_dwordx4 v[216:219], v4, s[20:23], s40 offen offset:0 sc1
  buffer_load_dwordx4 v[220:223], v4, s[20:23], s40 offen offset:1024 sc1
  s_waitcnt vmcnt(14)
  v_mfma_f32_32x32x16_bf16 v[128:143], v[80:83], v[224:227], v[128:143]
  v_mfma_f32_32x32x16_bf16 v[144:159], v[84:87], v[224:227], v[144:159]
  s_waitcnt vmcnt(13)
  v_mfma_f32_32x32x16_bf16 v[128:143], v[88:91], v[228:231], v[128:143]
  v_mfma_f32_32x32x16_bf16 v[144:159], v[92:95], v[228:231], v[144:159]
  s_add_u32 s40, s59, 65536
  buffer_load_dwordx4 v[224:227], v4, s[20:23], s40 offen offset:0 sc1
  buffer_load_dwordx4 v[228:231], v4, s[20:23], s40 offen offset:1024 sc1
  s_waitcnt lgkmcnt(8)
  s_waitcnt vmcnt(14)
  v_mfma_f32_32x32x16_bf16 v[160:175], v[96:99], v[232:235], v[160:175]
  v_mfma_f32_32x32x16_bf16 v[176:191], v[100:103], v[232:235], v[176:191]
  s_waitcnt vmcnt(13)
  v_mfma_f32_32x32x16_bf16 v[160:175], v[104:107], v[236:239], v[160:175]
  v_mfma_f32_32x32x16_bf16 v[176:191], v[108:111], v[236:239], v[176:191]
  s_add_u32 s40, s57, 81920
  buffer_load_dwordx4 v[232:235], v4, s[20:23], s40 offen offset:0 sc1
  buffer_load_dwordx4 v[236:239], v4, s[20:23], s40 offen offset:1024 sc1
  s_waitcnt lgkmcnt(0)
  s_waitcnt vmcnt(14)
  v_mfma_f32_32x32x16_bf16 v[128:143], v[112:115], v[240:243], v[128:143]
  v_mfma_f32_32x32x16_bf16 v[144:159], v[116:119], v[240:243], v[144:159]
  s_waitcnt vmcnt(13)
  v_mfma_f32_32x32x16_bf16 v[128:143], v[120:123], v[244:247], v[128:143]
  v_mfma_f32_32x32x16_bf16 v[144:159], v[124:127], v[244:247], v[144:159]
  s_add_u32 s40, s59, 98304
  buffer_load_dwordx4 v[240:243], v4, s[20:23], s40 offen offset:0 sc1
  buffer_load_dwordx4 v[244:247], v4, s[20:23], s40 offen offset:1024 sc1
  s_branch L_qj_58
L_qm_56:
  s_waitcnt vmcnt(14)
  v_mfma_f32_32x32x16_bf16 v[128:143], v[48:51], v[208:211], v[128:143]
  v_mfma_f32_32x32x16_bf16 v[144:159], v[52:55], v[208:211], v[144:159]
  s_waitcnt vmcnt(13)
  v_mfma_f32_32x32x16_bf16 v[128:143], v[56:59], v[212:215], v[128:143]
  v_mfma_f32_32x32x16_bf16 v[144:159], v[60:63], v[212:215], v[144:159]
  s_waitcnt vmcnt(7)
  ds_read_b64_tr_b16 v[112:113], v12 offset:0
  ds_read_b64_tr_b16 v[114:115], v12 offset:1024
  ds_read_b64_tr_b16 v[116:117], v13 offset:0
  ds_read_b64_tr_b16 v[118:119], v13 offset:1024
  ds_read_b64_tr_b16 v[120:121], v12 offset:2048
  ds_read_b64_tr_b16 v[122:123], v12 offset:3072
  ds_read_b64_tr_b16 v[124:125], v13 offset:2048
  ds_read_b64_tr_b16 v[126:127], v13 offset:3072
  s_waitcnt lgkmcnt(15)
  v_mfma_f32_32x32x16_bf16 v[160:175], v[64:67], v[216:219], v[160:175]
  v_mfma_f32_32x32x16_bf16 v[176:191], v[68:71], v[216:219], v[176:191]
  v_mfma_f32_32x32x16_bf16 v[160:175], v[72:75], v[220:223], v[160:175]
  v_mfma_f32_32x32x16_bf16 v[176:191], v[76:79], v[220:223], v[176:191]
  s_waitcnt vmcnt(0)
  v_and_b32 v15, 0xff, v6
  v_cmp_le_u32 vcc, 5, v15
  s_cmp_eq_u64 vcc, exec
  s_cbranch_scc0 L_qs_57
  s_cmp_eq_u32 s99, 0
  s_cbranch_scc1 L_aq_60
  buffer_inv sc1
  s_waitcnt vmcnt(0)
L_aq_60:
  s_add_u32 s40, s59, 0
  buffer_load_dwordx4 v[192:195], v4, s[20:23], s40 offen offset:0 sc1
  buffer_load_dwordx4 v[196:199], v4, s[20:23], s40 offen offset:1024 sc1
  s_add_u32 s40, s57, 16384
  buffer_load_dwordx4 v[200:203], v4, s[20:23], s40 offen offset:0 sc1
  buffer_load_dwordx4 v[204:207], v4, s[20:23], s40 offen offset:1024 sc1
  s_add_u32 s40, s59, 32768
  buffer_load_dwordx4 v[208:211], v4, s[20:23], s40 offen offset:0 sc1
  buffer_load_dwordx4 v[212:215], v4, s[20:23], s40 offen offset:1024 sc1
  s_add_u32 s40, s57, 49152
  buffer_load_dwordx4 v[216:219], v4, s[20:23], s40 offen offset:0 sc1
  buffer_load_dwordx4 v[220:223], v4, s[20:23], s40 offen offset:1024 sc1
  v_mfma_f32_32x32x16_bf16 v[128:143], v[80:83], v[224:227], v[128:143]
  v_mfma_f32_32x32x16_bf16 v[144:159], v[84:87], v[224:227], v[144:159]
  v_mfma_f32_32x32x16_bf16 v[128:143], v[88:91], v[228:231], v[128:143]
  v_mfma_f32_32x32x16_bf16 v[144:159], v[92:95], v[228:231], v[144:159]
  s_add_u32 s40, s59, 65536
  buffer_load_dwordx4 v[224:227], v4, s[20:23], s40 offen offset:0 sc1
  buffer_load_dwordx4 v[228:231], v4, s[20:23], s40 offen offset:1024 sc1
  s_waitcnt lgkmcnt(8)
  v_mfma_f32_32x32x16_bf16 v[160:175], v[96:99], v[232:235], v[160:175]
  v_mfma_f32_32x32x16_bf16 v[176:191], v[100:103], v[232:235], v[176:191]
  v_mfma_f32_32x32x16_bf16 v[160:175], v[104:107], v[236:239], v[160:175]
  v_mfma_f32_32x32x16_bf16 v[176:191], v[108:111], v[236:239], v[176:191]
  s_add_u32 s40, s57, 81920
  buffer_load_dwordx4 v[232:235], v4, s[20:23], s40 offen offset:0 sc1
  buffer_load_dwordx4 v[236:239], v4, s[20:23], s40 offen offset:1024 sc1
  s_waitcnt lgkmcnt(0)
  v_mfma_f32_32x32x16_bf16 v[128:143], v[112:115], v[240:243], v[128:143]
  v_mfma_f32_32x32x16_bf16 v[144:159], v[116:119], v[240:243], v[144:159]
  v_mfma_f32_32x32x16_bf16 v[128:143], v[120:123], v[244:247], v[128:143]
  v_mfma_f32_32x32x16_bf16 v[144:159], v[124:127], v[244:247], v[144:159]
  s_add_u32 s40, s59, 98304
  buffer_load_dwordx4 v[240:243], v4, s[20:23], s40 offen offset:0 sc1
  buffer_load_dwordx4 v[244:247], v4, s[20:23], s40 offen offset:1024 sc1
  s_branch L_qj_58
L_qs_57:
  v_mfma_f32_32x32x16_bf16 v[128:143], v[80:83], v[224:227], v[128:143]
  v_mfma_f32_32x32x16_bf16 v[144:159], v[84:87], v[224:227], v[144:159]
  v_mfma_f32_32x32x16_bf16 v[128:143], v[88:91], v[228:231], v[128:143]
  v_mfma_f32_32x32x16_bf16 v[144:159], v[92:95], v[228:231], v[144:159]
  s_waitcnt lgkmcnt(8)
  v_mfma_f32_32x32x16_bf16 v[160:175], v[96:99], v[232:235], v[160:175]
  v_mfma_f32_32x32x16_bf16 v[176:191], v[100:103], v[232:235], v[176:191]
  v_mfma_f32_32x32x16_bf16 v[160:175], v[104:107], v[236:239], v[160:175]
  v_mfma_f32_32x32x16_bf16 v[176:191], v[108:111], v[236:239], v[176:191]
  s_waitcnt lgkmcnt(0)
  v_mfma_f32_32x32x16_bf16 v[128:143], v[112:115], v[240:243], v[128:143]
  v_mfma_f32_32x32x16_bf16 v[144:159], v[116:119], v[240:243], v[144:159]
  v_mfma_f32_32x32x16_bf16 v[128:143], v[120:123], v[244:247], v[128:143]
  v_mfma_f32_32x32x16_bf16 v[144:159], v[124:127], v[244:247], v[144:159]
L_poll_61:
  buffer_load_dword v14, v11, s[20:23], s98 offen sc1
  s_waitcnt vmcnt(0)
  v_and_b32 v15, 0xff, v14
  v_cmp_le_u32 vcc, 5, v15
  s_cmp_eq_u64 vcc, exec
  s_cbranch_scc1 L_pd_62
  s_sleep 1
  s_sub_u32 s100, s100, 1
  s_cbranch_scc0 L_poll_61
  s_mov_b32 s100, 0
L_pd_62:
  s_cmp_eq_u32 s99, 0
  s_cbranch_scc1 L_aq_63
  buffer_inv sc1
  s_waitcnt vmcnt(0)
L_aq_63:
  s_add_u32 s40, s59, 0
  buffer_load_dwordx4 v[192:195], v4, s[20:23], s40 offen offset:0 sc1
  buffer_load_dwordx4 v[196:199], v4, s[20:23], s40 offen offset:1024 sc1
  s_add_u32 s40, s57, 16384
  buffer_load_dwordx4 v[200:203], v4, s[20:23], s40 offen offset:0 sc1
  buffer_load_dwordx4 v[204:207], v4, s[20:23], s40 offen offset:1024 sc1
  s_add_u32 s40, s59, 32768
  buffer_load_dwordx4 v[208:211], v4, s[20:23], s40 offen offset:0 sc1
  buffer_load_dwordx4 v[212:215], v4, s[20:23], s40 offen offset:1024 sc1
  s_add_u32 s40, s57, 49152
  buffer_load_dwordx4 v[216:219], v4, s[20:23], s40 offen offset:0 sc1
  buffer_load_dwordx4 v[220:223], v4, s[20:23], s40 offen offset:1024 sc1
  s_add_u32 s40, s59, 65536
  buffer_load_dwordx4 v[224:227], v4, s[20:23], s40 offen offset:0 sc1
  buffer_load_dwordx4 v[228:231], v4, s[20:23], s40 offen offset:1024 sc1
  s_add_u32 s40, s57, 81920
  buffer_load_dwordx4 v[232:235], v4, s[20:23], s40 offen offset:0 sc1
  buffer_load_dwordx4 v[236:239], v4, s[20:23], s40 offen offset:1024 sc1
  s_add_u32 s40, s59, 98304
  buffer_load_dwordx4 v[240:243], v4, s[20:23], s40 offen offset:0 sc1
  buffer_load_dwordx4 v[244:247], v4, s[20:23], s40 offen offset:1024 sc1
L_qj_58:
  s_waitcnt vmcnt(13)
  v_mfma_f32_32x32x16_bf16 v[160:175], v[16:19], v[192:195], v[160:175]
  v_mfma_f32_32x32x16_bf16 v[176:191], v[20:23], v[192:195], v[176:191]
  s_waitcnt vmcnt(12)
  v_mfma_f32_32x32x16_bf16 v[160:175], v[24:27], v[196:199], v[160:175]
  v_mfma_f32_32x32x16_bf16 v[176:191], v[28:31], v[196:199], v[176:191]
  s_waitcnt vmcnt(11)
  v_mfma_f32_32x32x16_bf16 v[128:143], v[32:35], v[200:203], v[128:143]
  v_mfma_f32_32x32x16_bf16 v[144:159], v[36:39], v[200:203], v[144:159]
  s_waitcnt vmcnt(10)
  v_mfma_f32_32x32x16_bf16 v[128:143], v[40:43], v[204:207], v[128:143]
  v_mfma_f32_32x32x16_bf16 v[144:159], v[44:47], v[204:207], v[144:159]
  s_waitcnt vmcnt(9)
  v_mfma_f32_32x32x16_bf16 v[160:175], v[48:51], v[208:211], v[160:175]
  v_mfma_f32_32x32x16_bf16 v[176:191], v[52:55], v[208:211], v[176:191]
  s_waitcnt vmcnt(8)
  v_mfma_f32_32x32x16_bf16 v[160:175], v[56:59], v[212:215], v[160:175]
  v_mfma_f32_32x32x16_bf16 v[176:191], v[60:63], v[212:215], v[176:191]
  s_waitcnt vmcnt(7)
  v_mfma_f32_32x32x16_bf16 v[128:143], v[64:67], v[216:219], v[128:143]
  v_mfma_f32_32x32x16_bf16 v[144:159], v[68:71], v[216:219], v[144:159]
  s_waitcnt vmcnt(6)
  v_mfma_f32_32x32x16_bf16 v[128:143], v[72:75], v[220:223], v[128:143]
  v_mfma_f32_32x32x16_bf16 v[144:159], v[76:79], v[220:223], v[144:159]
  s_waitcnt vmcnt(5)
  v_mfma_f32_32x32x16_bf16 v[160:175], v[80:83], v[224:227], v[160:175]
  v_mfma_f32_32x32x16_bf16 v[176:191], v[84:87], v[224:227], v[176:191]
  s_waitcnt vmcnt(4)
  v_mfma_f32_32x32x16_bf16 v[160:175], v[88:91], v[228:231], v[160:175]
  v_mfma_f32_32x32x16_bf16 v[176:191], v[92:95], v[228:231], v[176:191]
  s_waitcnt vmcnt(3)
  v_mfma_f32_32x32x16_bf16 v[128:143], v[96:99], v[232:235], v[128:143]
  v_mfma_f32_32x32x16_bf16 v[144:159], v[100:103], v[232:235], v[144:159]
  s_waitcnt vmcnt(2)
  v_mfma_f32_32x32x16_bf16 v[128:143], v[104:107], v[236:239], v[128:143]
  v_mfma_f32_32x32x16_bf16 v[144:159], v[108:111], v[236:239], v[144:159]
  s_waitcnt vmcnt(1)
  v_mfma_f32_32x32x16_bf16 v[160:175], v[112:115], v[240:243], v[160:175]
  v_mfma_f32_32x32x16_bf16 v[176:191], v[116:119], v[240:243], v[176:191]
  s_waitcnt vmcnt(0)
  v_mfma_f32_32x32x16_bf16 v[160:175], v[120:123], v[244:247], v[160:175]
  v_mfma_f32_32x32x16_bf16 v[176:191], v[124:127], v[244:247], v[176:191]
  v_add_u32 v8, s48, v4
  v_xor_b32 v9, 8192, v8
  v_xor_b32 v10, 16384, v8
  v_xor_b32 v11, 24576, v8
  v_lshlrev_b32 v16, 16, v248
  v_and_b32 v17, 0xffff0000, v248
  v_lshlrev_b32 v18, 16, v249
  v_and_b32 v19, 0xffff0000, v249
  v_lshlrev_b32 v20, 16, v250
  v_and_b32 v21, 0xffff0000, v250
  v_lshlrev_b32 v22, 16, v251
  v_and_b32 v23, 0xffff0000, v251
  v_lshlrev_b32 v24, 16, v252
  v_and_b32 v25, 0xffff0000, v252
  v_lshlrev_b32 v26, 16, v253
  v_and_b32 v27, 0xffff0000, v253
  v_lshlrev_b32 v28, 16, v254
  v_and_b32 v29, 0xffff0000, v254
  v_lshlrev_b32 v30, 16, v255
  v_and_b32 v31, 0xffff0000, v255
  s_cmp_lg_u32 s28, 0
  s_cbranch_scc1 L_m_f1
  ds_write_b128 v8, v[144:147] offset:0
  ds_write_b128 v8, v[148:151] offset:1024
  ds_write_b128 v8, v[152:155] offset:2048
  ds_write_b128 v8, v[156:159] offset:3072
  ds_write_b128 v8, v[160:163] offset:4096
  ds_write_b128 v8, v[164:167] offset:5120
  ds_write_b128 v8, v[168:171] offset:6144
  ds_write_b128 v8, v[172:175] offset:7168
  ds_write_b128 v8, v[176:179] offset:32768
  ds_write_b128 v8, v[180:183] offset:33792
  ds_write_b128 v8, v[184:187] offset:34816
  ds_write_b128 v8, v[188:191] offset:35840
  s_waitcnt lgkmcnt(0)
  s_barrier
  ds_read_b128 v[32:35], v9 offset:4096
  ds_read_b128 v[36:39], v9 offset:5120
  ds_read_b128 v[40:43], v9 offset:6144
  ds_read_b128 v[44:47], v9 offset:7168
  ds_read_b128 v[48:51], v10 offset:0
  ds_read_b128 v[52:55], v10 offset:1024
  ds_read_b128 v[56:59], v10 offset:2048
  ds_read_b128 v[60:63], v10 offset:3072
  ds_read_b128 v[64:67], v11 offset:32768
  ds_read_b128 v[68:71], v11 offset:33792
  ds_read_b128 v[72:75], v11 offset:34816
  ds_read_b128 v[76:79], v11 offset:35840
  s_waitcnt lgkmcnt(11)
  v_add_f32 v128, v128, v32
  v_add_f32 v129, v129, v33
  v_add_f32 v130, v130, v34
  v_add_f32 v131, v131, v35
  s_waitcnt lgkmcnt(10)
  v_add_f32 v132, v132, v36
  v_add_f32 v133, v133, v37
  v_add_f32 v134, v134, v38
  v_add_f32 v135, v135, v39
  s_waitcnt lgkmcnt(9)
  v_add_f32 v136, v136, v40
  v_add_f32 v137, v137, v41
  v_add_f32 v138, v138, v42
  v_add_f32 v139, v139, v43
  s_waitcnt lgkmcnt(8)
  v_add_f32 v140, v140, v44
  v_add_f32 v141, v141, v45
  v_add_f32 v142, v142, v46
  v_add_f32 v143, v143, v47
  s_waitcnt lgkmcnt(7)
  v_add_f32 v128, v128, v48
  v_add_f32 v129, v129, v49
  v_add_f32 v130, v130, v50
  v_add_f32 v131, v131, v51
  s_waitcnt lgkmcnt(6)
  v_add_f32 v132, v132, v52
  v_add_f32 v133, v133, v53
  v_add_f32 v134, v134, v54
  v_add_f32 v135, v135, v55
  s_waitcnt lgkmcnt(5)
  v_add_f32 v136, v136, v56
  v_add_f32 v137, v137, v57
  v_add_f32 v138, v138, v58
  v_add_f32 v139, v139, v59
  s_waitcnt lgkmcnt(4)
  v_add_f32 v140, v140, v60
  v_add_f32 v141, v141, v61
  v_add_f32 v142, v142, v62
  v_add_f32 v143, v143, v63
  s_waitcnt lgkmcnt(3)
  v_add_f32 v128, v128, v64
  v_add_f32 v129, v129, v65
  v_add_f32 v130, v130, v66
  v_add_f32 v131, v131, v67
  s_waitcnt lgkmcnt(2)
  v_add_f32 v132, v132, v68
  v_add_f32 v133, v133, v69
  v_add_f32 v134, v134, v70
  v_add_f32 v135, v135, v71
  s_waitcnt lgkmcnt(1)
  v_add_f32 v136, v136, v72
  v_add_f32 v137, v137, v73
  v_add_f32 v138, v138, v74
  v_add_f32 v139, v139, v75
  s_waitcnt lgkmcnt(0)
  v_add_f32 v140, v140, v76
  v_add_f32 v141, v141, v77
  v_add_f32 v142, v142, v78
  v_add_f32 v143, v143, v79
  v_cvt_pk_bf16_f32 v112, v128, v129
  v_cvt_pk_bf16_f32 v113, v130, v131
  v_cvt_pk_bf16_f32 v114, v132, v133
  v_cvt_pk_bf16_f32 v115, v134, v135
  v_cvt_pk_bf16_f32 v116, v136, v137
  v_cvt_pk_bf16_f32 v117, v138, v139
  v_cvt_pk_bf16_f32 v118, v140, v141
  v_cvt_pk_bf16_f32 v119, v142, v143
  s_branch L_m_f2
L_m_f1:
  ds_write_b128 v8, v[128:131] offset:4096
  ds_write_b128 v8, v[132:135] offset:5120
  ds_write_b128 v8, v[136:139] offset:6144
  ds_write_b128 v8, v[140:143] offset:7168
  ds_write_b128 v8, v[144:147] offset:32768
  ds_write_b128 v8, v[148:151] offset:33792
  ds_write_b128 v8, v[152:155] offset:34816
  ds_write_b128 v8, v[156:159] offset:35840
  ds_write_b128 v8, v[176:179] offset:0
  ds_write_b128 v8, v[180:183] offset:1024
  ds_write_b128 v8, v[184:187] offset:2048
  ds_write_b128 v8, v[188:191] offset:3072
  s_waitcnt lgkmcnt(0)
  s_barrier
  ds_read_b128 v[32:35], v9 offset:4096
  ds_read_b128 v[36:39], v9 offset:5120
  ds_read_b128 v[40:43], v9 offset:6144
  ds_read_b128 v[44:47], v9 offset:7168
  ds_read_b128 v[48:51], v10 offset:0
  ds_read_b128 v[52:55], v10 offset:1024
  ds_read_b128 v[56:59], v10 offset:2048
  ds_read_b128 v[60:63], v10 offset:3072
  ds_read_b128 v[64:67], v11 offset:32768
  ds_read_b128 v[68:71], v11 offset:33792
  ds_read_b128 v[72:75], v11 offset:34816
  ds_read_b128 v[76:79], v11 offset:35840
  s_waitcnt lgkmcnt(11)
  v_add_f32 v160, v160, v32
  v_add_f32 v161, v161, v33
  v_add_f32 v162, v162, v34
  v_add_f32 v163, v163, v35
  s_waitcnt lgkmcnt(10)
  v_add_f32 v164, v164, v36
  v_add_f32 v165, v165, v37
  v_add_f32 v166, v166, v38
  v_add_f32 v167, v167, v39
  s_waitcnt lgkmcnt(9)
  v_add_f32 v168, v168, v40
  v_add_f32 v169, v169, v41
  v_add_f32 v170, v170, v42
  v_add_f32 v171, v171, v43
  s_waitcnt lgkmcnt(8)
  v_add_f32 v172, v172, v44
  v_add_f32 v173, v173, v45
  v_add_f32 v174, v174, v46
  v_add_f32 v175, v175, v47
  s_waitcnt lgkmcnt(7)
  v_add_f32 v160, v160, v48
  v_add_f32 v161, v161, v49
  v_add_f32 v162, v162, v50
  v_add_f32 v163, v163, v51
  s_waitcnt lgkmcnt(6)
  v_add_f32 v164, v164, v52
  v_add_f32 v165, v165, v53
  v_add_f32 v166, v166, v54
  v_add_f32 v167, v167, v55
  s_waitcnt lgkmcnt(5)
  v_add_f32 v168, v168, v56
  v_add_f32 v169, v169, v57
  v_add_f32 v170, v170, v58
  v_add_f32 v171, v171, v59
  s_waitcnt lgkmcnt(4)
  v_add_f32 v172, v172, v60
  v_add_f32 v173, v173, v61
  v_add_f32 v174, v174, v62
  v_add_f32 v175, v175, v63
  s_waitcnt lgkmcnt(3)
  v_add_f32 v160, v160, v64
  v_add_f32 v161, v161, v65
  v_add_f32 v162, v162, v66
  v_add_f32 v163, v163, v67
  s_waitcnt lgkmcnt(2)
  v_add_f32 v164, v164, v68
  v_add_f32 v165, v165, v69
  v_add_f32 v166, v166, v70
  v_add_f32 v167, v167, v71
  s_waitcnt lgkmcnt(1)
  v_add_f32 v168, v168, v72
  v_add_f32 v169, v169, v73
  v_add_f32 v170, v170, v74
  v_add_f32 v171, v171, v75
  s_waitcnt lgkmcnt(0)
  v_add_f32 v172, v172, v76
  v_add_f32 v173, v173, v77
  v_add_f32 v174, v174, v78
  v_add_f32 v175, v175, v79
  v_cvt_pk_bf16_f32 v112, v160, v161
  v_cvt_pk_bf16_f32 v113, v162, v163
  v_cvt_pk_bf16_f32 v114, v164, v165
  v_cvt_pk_bf16_f32 v115, v166, v167
  v_cvt_pk_bf16_f32 v116, v168, v169
  v_cvt_pk_bf16_f32 v117, v170, v171
  v_cvt_pk_bf16_f32 v118, v172, v173
  v_cvt_pk_bf16_f32 v119, v174, v175
L_m_f2:
  v_lshlrev_b32 v128, 16, v112
  v_and_b32 v129, 0xffff0000, v112
  v_lshlrev_b32 v130, 16, v113
  v_and_b32 v131, 0xffff0000, v113
  v_lshlrev_b32 v132, 16, v114
  v_and_b32 v133, 0xffff0000, v114
  v_lshlrev_b32 v134, 16, v115
  v_and_b32 v135, 0xffff0000, v115
  v_lshlrev_b32 v136, 16, v116
  v_and_b32 v137, 0xffff0000, v116
  v_lshlrev_b32 v138, 16, v117
  v_and_b32 v139, 0xffff0000, v117
  v_lshlrev_b32 v140, 16, v118
  v_and_b32 v141, 0xffff0000, v118
  v_lshlrev_b32 v142, 16, v119
  v_and_b32 v143, 0xffff0000, v119
  v_add_f32 v128, v128, v16
  v_add_f32 v129, v129, v17
  v_add_f32 v130, v130, v18
  v_add_f32 v131, v131, v19
  v_add_f32 v132, v132, v20
  v_add_f32 v133, v133, v21
  v_add_f32 v134, v134, v22
  v_add_f32 v135, v135, v23
  v_add_f32 v136, v136, v24
  v_add_f32 v137, v137, v25
  v_add_f32 v138, v138, v26
  v_add_f32 v139, v139, v27
  v_add_f32 v140, v140, v28
  v_add_f32 v141, v141, v29
  v_add_f32 v142, v142, v30
  v_add_f32 v143, v143, v31
  v_cvt_pk_bf16_f32 v112, v128, v129
  v_cvt_pk_bf16_f32 v113, v130, v131
  v_cvt_pk_bf16_f32 v114, v132, v133
  v_cvt_pk_bf16_f32 v115, v134, v135
  v_cvt_pk_bf16_f32 v116, v136, v137
  v_cvt_pk_bf16_f32 v117, v138, v139
  v_cvt_pk_bf16_f32 v118, v140, v141
  v_cvt_pk_bf16_f32 v119, v142, v143
  s_nop 1
  v_permlane32_swap_b32 v112, v114
  v_permlane32_swap_b32 v113, v115
  v_permlane32_swap_b32 v116, v118
  v_permlane32_swap_b32 v117, v119
  s_nop 1
  buffer_store_dwordx4 v[112:115], v7, s[16:19], s32 offen offset:0
  buffer_store_dwordx4 v[116:119], v7, s[16:19], s32 offen offset:32
  s_branch L_m_fin
L_m_slow:
  s_mov_b32 s60, 1
  s_waitcnt vmcnt(0)
  v_mov_b32 v48, 0xff800000
  v_mov_b32 v49, 0xff800000
  v_mov_b32 v50, 0xff800000
  v_mov_b32 v51, 0xff800000
  s_mov_b32 s55, s54
  s_mov_b32 s61, 16
L_m_slow_loop:
  buffer_load_dwordx4 v[160:163], v4, s[20:23], s55 offen
  buffer_load_dwordx4 v[164:167], v4, s[20:23], s55 offen offset:1024
  s_add_u32 s55, s55, 16384
  s_waitcnt vmcnt(0)
  v_mfma_f32_32x32x16_bf16 v[112:127], v[160:163], v[16:19], 0
  v_mfma_f32_32x32x16_bf16 v[112:127], v[164:167], v[20:23], v[112:127]
  s_nop 15
  v_max3_f32 v48, v112, v113, v48
  v_max3_f32 v48, v114, v115, v48
  v_max3_f32 v48, v116, v117, v48
  v_max3_f32 v48, v118, v119, v48
  v_max3_f32 v48, v120, v121, v48
  v_max3_f32 v48, v122, v123, v48
  v_max3_f32 v48, v124, v125, v48
  v_max3_f32 v48, v126, v127, v48
  s_nop 1
  v_mfma_f32_32x32x16_bf16 v[112:127], v[160:163], v[24:27], 0
  v_mfma_f32_32x32x16_bf16 v[112:127], v[164:167], v[28:31], v[112:127]
  s_nop 15
  v_max3_f32 v49, v112, v113, v49
  v_max3_f32 v49, v114, v115, v49
  v_max3_f32 v49, v116, v117, v49
  v_max3_f32 v49, v118, v119, v49
  v_max3_f32 v49, v120, v121, v49
  v_max3_f32 v49, v122, v123, v49
  v_max3_f32 v49, v124, v125, v49
  v_max3_f32 v49, v126, v127, v49
  s_nop 1
  v_mfma_f32_32x32x16_bf16 v[112:127], v[160:163], v[32:35], 0
  v_mfma_f32_32x32x16_bf16 v[112:127], v[164:167], v[36:39], v[112:127]
  s_nop 15
  v_max3_f32 v50, v112, v113, v50
  v_max3_f32 v50, v114, v115, v50
  v_max3_f32 v50, v116, v117, v50
  v_max3_f32 v50, v118, v119, v50
  v_max3_f32 v50, v120, v121, v50
  v_max3_f32 v50, v122, v123, v50
  v_max3_f32 v50, v124, v125, v50
  v_max3_f32 v50, v126, v127, v50
  s_nop 1
  v_mfma_f32_32x32x16_bf16 v[112:127], v[160:163], v[40:43], 0
  v_mfma_f32_32x32x16_bf16 v[112:127], v[164:167], v[44:47], v[112:127]
  s_nop 15
  v_max3_f32 v51, v112, v113, v51
  v_max3_f32 v51, v114, v115, v51
  v_max3_f32 v51, v116, v117, v51
  v_max3_f32 v51, v118, v119, v51
  v_max3_f32 v51, v120, v121, v51
  v_max3_f32 v51, v122, v123, v51
  v_max3_f32 v51, v124, v125, v51
  v_max3_f32 v51, v126, v127, v51
  s_nop 1
  s_sub_u32 s61, s61, 1
  s_cmp_lg_u32 s61, 0
  s_cbranch_scc1 L_m_slow_loop
  v_lshlrev_b32 v9, 2, v1
  s_lshl_b32 s53, s3, 10
  v_mov_b32 v7, v48
  s_nop 1
  v_permlane32_swap_b32 v7, v48
  s_nop 1
  v_max_f32 v48, v48, v7
  s_lshl_b32 s52, s40, 8
  v_add_u32 v52, s52, v9
  v_add_u32 v10, s53, v52
  ds_write_b32 v10, v48
  v_mov_b32 v7, v49
  s_nop 1
  v_permlane32_swap_b32 v7, v49
  s_nop 1
  v_max_f32 v49, v49, v7
  s_lshl_b32 s52, s41, 8
  v_add_u32 v53, s52, v9
  v_add_u32 v10, s53, v53
  ds_write_b32 v10, v49
  v_mov_b32 v7, v50
  s_nop 1
  v_permlane32_swap_b32 v7, v50
  s_nop 1
  v_max_f32 v50, v50, v7
  s_lshl_b32 s52, s42, 8
  v_add_u32 v54, s52, v9
  v_add_u32 v10, s53, v54
  ds_write_b32 v10, v50
  v_mov_b32 v7, v51
  s_nop 1
  v_permlane32_swap_b32 v7, v51
  s_nop 1
  v_max_f32 v51, v51, v7
  s_lshl_b32 s52, s43, 8
  v_add_u32 v55, s52, v9
  v_add_u32 v10, s53, v55
  ds_write_b32 v10, v51
  s_waitcnt lgkmcnt(0)
  s_barrier
  ds_read_b32 v112, v52 offset:0
  ds_read_b32 v113, v52 offset:1024
  ds_read_b32 v114, v52 offset:2048
  ds_read_b32 v115, v52 offset:3072
  ds_read_b32 v116, v53 offset:0
  ds_read_b32 v117, v53 offset:1024
  ds_read_b32 v118, v53 offset:2048
  ds_read_b32 v119, v53 offset:3072
  ds_read_b32 v120, v54 offset:0
  ds_read_b32 v121, v54 offset:1024
  ds_read_b32 v122, v54 offset:2048
  ds_read_b32 v123, v54 offset:3072
  ds_read_b32 v124, v55 offset:0
  ds_read_b32 v125, v55 offset:1024
  ds_read_b32 v126, v55 offset:2048
  ds_read_b32 v127, v55 offset:3072
  s_waitcnt lgkmcnt(0)
  s_barrier
  v_max3_f32 v6, v112, v113, v114
  v_max_f32 v6, v6, v115
  v_cvt_pk_bf16_f32 v6, -v6, 0
  v_cndmask_b32_e64 v22, v22, v6, s[34:35]
  v_max3_f32 v6, v116, v117, v118
  v_max_f32 v6, v6, v119
  v_cvt_pk_bf16_f32 v6, -v6, 0
  v_cndmask_b32_e64 v30, v30, v6, s[34:35]
  v_max3_f32 v6, v120, v121, v122
  v_max_f32 v6, v6, v123
  v_cvt_pk_bf16_f32 v6, -v6, 0
  v_cndmask_b32_e64 v38, v38, v6, s[34:35]
  v_max3_f32 v6, v124, v125, v126
  v_max_f32 v6, v6, v127
  v_cvt_pk_bf16_f32 v6, -v6, 0
  v_cndmask_b32_e64 v46, v46, v6, s[34:35]
  s_mov_b32 s57, -1
  s_mov_b32 s59, -1
  s_branch L_m_main
L_m_load:
  s_sub_u32 s29, s3, 4
  v_lshrrev_b32 v10, 3, v1
  v_and_b32 v11, 7, v1
  v_bfe_u32 v9, v1, 4, 1
  v_lshlrev_b32 v9, 2, v9
  v_xor_b32 v9, v9, v11
  v_min_u32 v9, 6, v9
  v_mul_u32_u24 v18, 2688, v10
  v_lshl_add_u32 v18, v9, 4, v18
  v_add_u32 v19, 20480, v18
  v_lshrrev_b32 v9, 1, v10
  v_xor_b32 v9, v9, v11
  v_mul_u32_u24 v16, 896, v10
  v_xor_b32 v12, 4, v9
  v_lshl_add_u32 v17, v12, 4, v16
  v_lshl_add_u32 v16, v9, 4, v16
  v_add_u32 v17, 6144, v17
  s_lshr_b32 s26, s61, 1
  s_add_u32 s34, s26, s92
  s_mul_i32 s35, s34, 37
  s_lshr_b32 s35, s35, 8
  s_mul_i32 s35, s35, 7
  s_sub_u32 s34, s34, s35
  s_lshl_b32 s40, s34, 7
  s_add_u32 s41, s40, 128
  s_cmp_eq_u32 s41, 896
  s_cselect_b32 s41, 0, s41
  s_add_u32 s42, s41, 128
  s_cmp_eq_u32 s42, 896
  s_cselect_b32 s42, 0, s42
  s_add_u32 s43, s42, 128
  s_cmp_eq_u32 s43, 896
  s_cselect_b32 s43, 0, s43
  s_add_u32 s44, s43, 128
  s_cmp_eq_u32 s44, 896
  s_cselect_b32 s44, 0, s44
  s_add_u32 s45, s44, 128
  s_cmp_eq_u32 s45, 896
  s_cselect_b32 s45, 0, s45
  s_add_u32 s46, s45, 128
  s_cmp_eq_u32 s46, 896
  s_cselect_b32 s46, 0, s46
  s_lshl_b32 s31, s26, 2
  s_add_u32 s31, s31, s29
  s_mul_i32 s31, s31, 28672
  s_mul_i32 s30, s29, 43008
  s_mul_i32 s33, s92, 112
  s_and_b32 s34, s61, 1
  s_mul_i32 s35, s34, 896
  s_add_u32 s32, s30, s33
  s_add_u32 s32, s32, s35
  s_add_u32 s32, s32, 896
  s_mul_i32 s35, s34, 48
  s_add_u32 s30, s30, s33
  s_add_u32 s30, s30, s35
  s_lshl_b32 s33, s29, 11
  s_lshl_b32 s38, s29, 12
  s_lshl_b32 s39, s29, 10
  s_waitcnt lgkmcnt(0)
  s_mov_b32 s24, s56
  s_mov_b32 s25, s57
  s_mov_b32 s26, 0x126000
  s_mov_b32 s27, 0x00020000
  s_mov_b32 s16, s4
  s_mov_b32 s17, s5
  s_mov_b32 s18, 0x1c0000
  s_mov_b32 s19, 0x00020000
  s_add_u32 s36, s38, 0
  s_mov_b32 m0, s36
  s_add_u32 s35, s31, s40
  buffer_load_dwordx4 v16, s[16:19], s35 offen  lds
  buffer_load_dwordx4 v17, s[16:19], s35 offen offset:1024  lds
  s_add_u32 s36, s38, 2048
  s_mov_b32 m0, s36
  s_add_u32 s35, s35, 14336
  buffer_load_dwordx4 v16, s[16:19], s35 offen  lds
  buffer_load_dwordx4 v17, s[16:19], s35 offen offset:1024  lds
  s_add_u32 s36, s33, 98304
  s_mov_b32 m0, s36
  s_mul_i32 s37, s40, 1344
  s_add_u32 s37, s37, s32
  buffer_load_dwordx4 v18, s[24:27], s37 offen lds
  buffer_load_dwordx4 v19, s[24:27], s37 offen offset:1024 lds
  s_barrier
  s_add_u32 s36, s38, 16384
  s_mov_b32 m0, s36
  s_add_u32 s35, s31, s41
  buffer_load_dwordx4 v16, s[16:19], s35 offen  lds
  buffer_load_dwordx4 v17, s[16:19], s35 offen offset:1024  lds
  s_add_u32 s36, s38, 18432
  s_mov_b32 m0, s36
  s_add_u32 s35, s35, 14336
  buffer_load_dwordx4 v16, s[16:19], s35 offen  lds
  buffer_load_dwordx4 v17, s[16:19], s35 offen offset:1024  lds
  s_add_u32 s36, s33, 106496
  s_mov_b32 m0, s36
  s_mul_i32 s37, s41, 1344
  s_add_u32 s37, s37, s32
  buffer_load_dwordx4 v18, s[24:27], s37 offen lds
  buffer_load_dwordx4 v19, s[24:27], s37 offen offset:1024 lds
  s_barrier
  s_add_u32 s36, s38, 32768
  s_mov_b32 m0, s36
  s_add_u32 s35, s31, s42
  buffer_load_dwordx4 v16, s[16:19], s35 offen  lds
  buffer_load_dwordx4 v17, s[16:19], s35 offen offset:1024  lds
  s_add_u32 s36, s38, 34816
  s_mov_b32 m0, s36
  s_add_u32 s35, s35, 14336
  buffer_load_dwordx4 v16, s[16:19], s35 offen  lds
  buffer_load_dwordx4 v17, s[16:19], s35 offen offset:1024  lds
  s_add_u32 s36, s33, 114688
  s_mov_b32 m0, s36
  s_mul_i32 s37, s42, 1344
  s_add_u32 s37, s37, s32
  buffer_load_dwordx4 v18, s[24:27], s37 offen lds
  buffer_load_dwordx4 v19, s[24:27], s37 offen offset:1024 lds
  s_lshr_b32 s93, s2, 3
  s_cmp_lt_u32 s93, 4
  s_cselect_b32 s101, 1, 0
  s_cselect_b32 s28, 0, 4
  s_sub_u32 s93, s93, s28
  s_and_b32 s94, s93, 1
  s_lshl_b32 s28, s92, 1
  s_add_u32 s94, s94, s28
  s_bfe_u32 s95, s93, 0x10001
  s_lshr_b32 s96, s93, 2
  s_lshr_b32 s97, s93, 1
  s_lshl_b32 s98, s94, 10
  s_add_u32 s98, s98, 0x7f8000
  s_mov_b32 s20, s6
  s_mov_b32 s21, s7
  s_mov_b32 s22, 0x2000000
  s_mov_b32 s23, 0x00020000
  s_mov_b32 s52, s58
  s_mov_b32 s53, s59
  s_mov_b32 s54, 0x100
  s_mov_b32 s55, 0x00020000
  v_lshrrev_b32 v9, 2, v1
  v_mul_u32_u24 v21, 2688, v9
  v_and_b32 v9, 3, v1
  v_lshl_add_u32 v21, v9, 4, v21
  v_lshlrev_b32 v29, 2, v1
  v_bfe_u32 v8, v1, 2, 2
  v_lshl_add_u32 v8, v3, 3, v8
  v_bfe_u32 v12, v1, 4, 1
  v_lshlrev_b32 v13, 5, v12
  v_lshl_add_u32 v9, v9, 3, v13
  s_and_b32 s34, s61, 1
  s_lshl_b32 s34, s34, 3
  s_add_u32 s34, s34, s39
  s_add_u32 s34, s34, 16384
  v_lshl_add_u32 v24, v8, 6, v9
  v_add_u32 v24, s34, v24
  v_bfe_u32 v13, v1, 3, 1
  v_lshlrev_b32 v13, 6, v13
  v_add_u32 v14, 56, v9
  v_xor_b32 v9, v9, v13
  v_xor_b32 v14, v14, v13
  s_bitcmp1_b32 s29, 0
  s_cselect_b64 vcc, -1, 0
  v_cndmask_b32 v9, v9, v14, vcc
  v_lshl_add_u32 v22, v8, 7, v9
  v_add_u32 v22, 98304, v22
  v_xor_b32 v9, v12, v1
  v_and_b32 v9, 1, v9
  v_cmp_eq_u32 vcc, 0, v9
  v_mov_b32 v9, 0x3f803f80
  v_cndmask_b32 v32, 0, v9, vcc
  v_cndmask_b32 v33, 0, v9, vcc
  v_cndmask_b32 v34, 0, v9, vcc
  v_cndmask_b32 v35, 0, v9, vcc
  v_add_u32 v25, 155648, v29
  s_waitcnt vmcnt(12)
  s_barrier
  s_add_u32 s36, s38, 49152
  s_mov_b32 m0, s36
  s_add_u32 s35, s31, s43
  buffer_load_dwordx4 v16, s[16:19], s35 offen  lds
  buffer_load_dwordx4 v17, s[16:19], s35 offen offset:1024  lds
  s_add_u32 s36, s38, 51200
  s_mov_b32 m0, s36
  s_add_u32 s35, s35, 14336
  buffer_load_dwordx4 v16, s[16:19], s35 offen  lds
  buffer_load_dwordx4 v17, s[16:19], s35 offen offset:1024  lds
  s_add_u32 s36, s33, 122880
  s_mov_b32 m0, s36
  s_mul_i32 s37, s43, 1344
  s_add_u32 s37, s37, s32
  buffer_load_dwordx4 v18, s[24:27], s37 offen lds
  buffer_load_dwordx4 v19, s[24:27], s37 offen offset:1024 lds
  s_cmp_lt_u32 s29, 2
  s_cbranch_scc1 L_cs_64
  ds_read_b64_tr_b16 v[48:49], v22 offset:0
  ds_read_b64_tr_b16 v[50:51], v22 offset:512
  ds_read_b64_tr_b16 v[52:53], v22 offset:2048
  ds_read_b64_tr_b16 v[54:55], v22 offset:2560
  ds_read_b64_tr_b16 v[56:57], v22 offset:4096
  ds_read_b64_tr_b16 v[58:59], v22 offset:4608
  ds_read_b64_tr_b16 v[60:61], v22 offset:6144
  ds_read_b64_tr_b16 v[62:63], v22 offset:6656
  s_waitcnt lgkmcnt(6)
  v_mfma_f32_16x16x32_bf16 v[36:39], v[32:35], v[48:51], 0
  s_waitcnt lgkmcnt(4)
  v_mfma_f32_16x16x32_bf16 v[40:43], v[32:35], v[52:55], 0
  s_waitcnt lgkmcnt(2)
  v_mfma_f32_16x16x32_bf16 v[36:39], v[32:35], v[56:59], v[36:39]
  s_waitcnt lgkmcnt(0)
  v_mfma_f32_16x16x32_bf16 v[40:43], v[32:35], v[60:63], v[40:43]
L_cs_64:
  s_waitcnt vmcnt(12)
  s_barrier
  s_add_u32 s36, s38, 65536
  s_mov_b32 m0, s36
  s_add_u32 s35, s31, s44
  buffer_load_dwordx4 v16, s[16:19], s35 offen  lds
  buffer_load_dwordx4 v17, s[16:19], s35 offen offset:1024  lds
  s_add_u32 s36, s38, 67584
  s_mov_b32 m0, s36
  s_add_u32 s35, s35, 14336
  buffer_load_dwordx4 v16, s[16:19], s35 offen  lds
  buffer_load_dwordx4 v17, s[16:19], s35 offen offset:1024  lds
  s_add_u32 s36, s33, 131072
  s_mov_b32 m0, s36
  s_mul_i32 s37, s44, 1344
  s_add_u32 s37, s37, s32
  buffer_load_dwordx4 v18, s[24:27], s37 offen lds
  buffer_load_dwordx4 v19, s[24:27], s37 offen offset:1024 lds
  s_cmp_lt_u32 s29, 2
  s_cbranch_scc1 L_cs_65
  ds_read_b64_tr_b16 v[48:49], v22 offset:8192
  ds_read_b64_tr_b16 v[50:51], v22 offset:8704
  ds_read_b64_tr_b16 v[52:53], v22 offset:10240
  ds_read_b64_tr_b16 v[54:55], v22 offset:10752
  ds_read_b64_tr_b16 v[56:57], v22 offset:12288
  ds_read_b64_tr_b16 v[58:59], v22 offset:12800
  ds_read_b64_tr_b16 v[60:61], v22 offset:14336
  ds_read_b64_tr_b16 v[62:63], v22 offset:14848
  s_waitcnt lgkmcnt(6)
  v_mfma_f32_16x16x32_bf16 v[36:39], v[32:35], v[48:51], v[36:39]
  s_waitcnt lgkmcnt(4)
  v_mfma_f32_16x16x32_bf16 v[40:43], v[32:35], v[52:55], v[40:43]
  s_waitcnt lgkmcnt(2)
  v_mfma_f32_16x16x32_bf16 v[36:39], v[32:35], v[56:59], v[36:39]
  s_waitcnt lgkmcnt(0)
  v_mfma_f32_16x16x32_bf16 v[40:43], v[32:35], v[60:63], v[40:43]
L_cs_65:
  s_waitcnt vmcnt(12)
  s_barrier
  s_add_u32 s36, s38, 81920
  s_mov_b32 m0, s36
  s_add_u32 s35, s31, s45
  buffer_load_dwordx4 v16, s[16:19], s35 offen  lds
  buffer_load_dwordx4 v17, s[16:19], s35 offen offset:1024  lds
  s_add_u32 s36, s38, 83968
  s_mov_b32 m0, s36
  s_add_u32 s35, s35, 14336
  buffer_load_dwordx4 v16, s[16:19], s35 offen  lds
  buffer_load_dwordx4 v17, s[16:19], s35 offen offset:1024  lds
  s_add_u32 s36, s33, 139264
  s_mov_b32 m0, s36
  s_mul_i32 s37, s45, 1344
  s_add_u32 s37, s37, s32
  buffer_load_dwordx4 v18, s[24:27], s37 offen lds
  buffer_load_dwordx4 v19, s[24:27], s37 offen offset:1024 lds
  s_add_u32 s36, s38, 0
  s_mov_b32 m0, s36
  s_add_u32 s35, s31, s46
  buffer_load_dwordx4 v16, s[16:19], s35 offen  lds
  buffer_load_dwordx4 v17, s[16:19], s35 offen offset:1024  lds
  s_add_u32 s36, s38, 2048
  s_mov_b32 m0, s36
  s_add_u32 s35, s35, 14336
  buffer_load_dwordx4 v16, s[16:19], s35 offen  lds
  buffer_load_dwordx4 v17, s[16:19], s35 offen offset:1024  lds
  s_add_u32 s36, s33, 98304
  s_mov_b32 m0, s36
  s_mul_i32 s37, s46, 1344
  s_add_u32 s37, s37, s32
  buffer_load_dwordx4 v18, s[24:27], s37 offen lds
  buffer_load_dwordx4 v19, s[24:27], s37 offen offset:1024 lds
  s_cmp_lt_u32 s29, 2
  s_cbranch_scc1 L_cs_66
  ds_read_b64_tr_b16 v[48:49], v22 offset:16384
  ds_read_b64_tr_b16 v[50:51], v22 offset:16896
  ds_read_b64_tr_b16 v[52:53], v22 offset:18432
  ds_read_b64_tr_b16 v[54:55], v22 offset:18944
  ds_read_b64_tr_b16 v[56:57], v22 offset:20480
  ds_read_b64_tr_b16 v[58:59], v22 offset:20992
  ds_read_b64_tr_b16 v[60:61], v22 offset:22528
  ds_read_b64_tr_b16 v[62:63], v22 offset:23040
  s_waitcnt lgkmcnt(6)
  v_mfma_f32_16x16x32_bf16 v[36:39], v[32:35], v[48:51], v[36:39]
  s_waitcnt lgkmcnt(4)
  v_mfma_f32_16x16x32_bf16 v[40:43], v[32:35], v[52:55], v[40:43]
  s_waitcnt lgkmcnt(2)
  v_mfma_f32_16x16x32_bf16 v[36:39], v[32:35], v[56:59], v[36:39]
  s_waitcnt lgkmcnt(0)
  v_mfma_f32_16x16x32_bf16 v[40:43], v[32:35], v[60:63], v[40:43]
L_cs_66:
  s_waitcnt vmcnt(18)
  s_barrier
  s_add_u32 s36, s39, 16384
  s_mov_b32 m0, s36
  s_mul_i32 s37, s40, 1344
  s_add_u32 s37, s37, s30
  buffer_load_dwordx4 v21, s[24:27], s37 offen lds
  s_add_u32 s36, s39, 20480
  s_mov_b32 m0, s36
  s_mul_i32 s37, s41, 1344
  s_add_u32 s37, s37, s30
  buffer_load_dwordx4 v21, s[24:27], s37 offen lds
  s_add_u32 s36, s39, 24576
  s_mov_b32 m0, s36
  s_mul_i32 s37, s42, 1344
  s_add_u32 s37, s37, s30
  buffer_load_dwordx4 v21, s[24:27], s37 offen lds
  s_add_u32 s36, s39, 28672
  s_mov_b32 m0, s36
  s_mul_i32 s37, s43, 1344
  s_add_u32 s37, s37, s30
  buffer_load_dwordx4 v21, s[24:27], s37 offen lds
  s_cmp_lt_u32 s29, 2
  s_cbranch_scc1 L_cs_67
  ds_read_b64_tr_b16 v[48:49], v22 offset:24576
  ds_read_b64_tr_b16 v[50:51], v22 offset:25088
  ds_read_b64_tr_b16 v[52:53], v22 offset:26624
  ds_read_b64_tr_b16 v[54:55], v22 offset:27136
  ds_read_b64_tr_b16 v[56:57], v22 offset:28672
  ds_read_b64_tr_b16 v[58:59], v22 offset:29184
  ds_read_b64_tr_b16 v[60:61], v22 offset:30720
  ds_read_b64_tr_b16 v[62:63], v22 offset:31232
  s_waitcnt lgkmcnt(6)
  v_mfma_f32_16x16x32_bf16 v[36:39], v[32:35], v[48:51], v[36:39]
  s_waitcnt lgkmcnt(4)
  v_mfma_f32_16x16x32_bf16 v[40:43], v[32:35], v[52:55], v[40:43]
  s_waitcnt lgkmcnt(2)
  v_mfma_f32_16x16x32_bf16 v[36:39], v[32:35], v[56:59], v[36:39]
  s_waitcnt lgkmcnt(0)
  v_mfma_f32_16x16x32_bf16 v[40:43], v[32:35], v[60:63], v[40:43]
L_cs_67:
  s_waitcnt vmcnt(16)
  s_barrier
  buffer_load_dwordx2 v[30:31], off, s[52:55], 0
  s_add_u32 s36, s39, 32768
  s_mov_b32 m0, s36
  s_mul_i32 s37, s44, 1344
  s_add_u32 s37, s37, s30
  buffer_load_dwordx4 v21, s[24:27], s37 offen lds
  s_add_u32 s36, s39, 36864
  s_mov_b32 m0, s36
  s_mul_i32 s37, s45, 1344
  s_add_u32 s37, s37, s30
  buffer_load_dwordx4 v21, s[24:27], s37 offen lds
  s_add_u32 s36, s39, 40960
  s_mov_b32 m0, s36
  s_mul_i32 s37, s46, 1344
  s_add_u32 s37, s37, s30
  buffer_load_dwordx4 v21, s[24:27], s37 offen lds
  s_cmp_lt_u32 s29, 2
  s_cbranch_scc1 L_cs_68
  ds_read_b64_tr_b16 v[48:49], v22 offset:32768
  ds_read_b64_tr_b16 v[50:51], v22 offset:33280
  ds_read_b64_tr_b16 v[52:53], v22 offset:34816
  ds_read_b64_tr_b16 v[54:55], v22 offset:35328
  ds_read_b64_tr_b16 v[56:57], v22 offset:36864
  ds_read_b64_tr_b16 v[58:59], v22 offset:37376
  ds_read_b64_tr_b16 v[60:61], v22 offset:38912
  ds_read_b64_tr_b16 v[62:63], v22 offset:39424
  s_waitcnt lgkmcnt(6)
  v_mfma_f32_16x16x32_bf16 v[36:39], v[32:35], v[48:51], v[36:39]
  s_waitcnt lgkmcnt(4)
  v_mfma_f32_16x16x32_bf16 v[40:43], v[32:35], v[52:55], v[40:43]
  s_waitcnt lgkmcnt(2)
  v_mfma_f32_16x16x32_bf16 v[36:39], v[32:35], v[56:59], v[36:39]
  s_waitcnt lgkmcnt(0)
  v_mfma_f32_16x16x32_bf16 v[40:43], v[32:35], v[60:63], v[40:43]
L_cs_68:
  s_waitcnt vmcnt(14)
  s_barrier
  s_cmp_lt_u32 s29, 2
  s_cbranch_scc1 L_cs_69
  ds_read_b64_tr_b16 v[48:49], v22 offset:40960
  ds_read_b64_tr_b16 v[50:51], v22 offset:41472
  ds_read_b64_tr_b16 v[52:53], v22 offset:43008
  ds_read_b64_tr_b16 v[54:55], v22 offset:43520
  ds_read_b64_tr_b16 v[56:57], v22 offset:45056
  ds_read_b64_tr_b16 v[58:59], v22 offset:45568
  ds_read_b64_tr_b16 v[60:61], v22 offset:47104
  ds_read_b64_tr_b16 v[62:63], v22 offset:47616
  s_waitcnt lgkmcnt(6)
  v_mfma_f32_16x16x32_bf16 v[36:39], v[32:35], v[48:51], v[36:39]
  s_waitcnt lgkmcnt(4)
  v_mfma_f32_16x16x32_bf16 v[40:43], v[32:35], v[52:55], v[40:43]
  s_waitcnt lgkmcnt(2)
  v_mfma_f32_16x16x32_bf16 v[36:39], v[32:35], v[56:59], v[36:39]
  s_waitcnt lgkmcnt(0)
  v_mfma_f32_16x16x32_bf16 v[40:43], v[32:35], v[60:63], v[40:43]
L_cs_69:
  s_waitcnt vmcnt(8)
  s_barrier
  s_cmp_lt_u32 s29, 2
  s_cbranch_scc1 L_cs_70
  ds_read_b64_tr_b16 v[48:49], v22 offset:0
  ds_read_b64_tr_b16 v[50:51], v22 offset:512
  ds_read_b64_tr_b16 v[52:53], v22 offset:2048
  ds_read_b64_tr_b16 v[54:55], v22 offset:2560
  ds_read_b64_tr_b16 v[56:57], v22 offset:4096
  ds_read_b64_tr_b16 v[58:59], v22 offset:4608
  ds_read_b64_tr_b16 v[60:61], v22 offset:6144
  ds_read_b64_tr_b16 v[62:63], v22 offset:6656
  s_waitcnt lgkmcnt(6)
  v_mfma_f32_16x16x32_bf16 v[36:39], v[32:35], v[48:51], v[36:39]
  s_waitcnt lgkmcnt(4)
  v_mfma_f32_16x16x32_bf16 v[40:43], v[32:35], v[52:55], v[40:43]
  s_waitcnt lgkmcnt(2)
  v_mfma_f32_16x16x32_bf16 v[36:39], v[32:35], v[56:59], v[36:39]
  s_waitcnt lgkmcnt(0)
  v_mfma_f32_16x16x32_bf16 v[40:43], v[32:35], v[60:63], v[40:43]
  s_and_b32 s34, s29, 1
  s_lshl_b32 s34, s34, 7
  v_add_u32 v9, s34, v25
  s_nop 7
  v_add_f32 v36, v36, v40
  v_add_f32 v37, v37, v41
  s_mov_b64 exec, 0xffff
  ds_write2_b32 v9, v36, v37 offset1:16
  s_mov_b64 exec, -1
L_cs_70:
  s_cmp_lg_u32 s29, 0
  s_cbranch_scc1 L_m_cskip
  s_getreg_b32 s35, hwreg(HW_REG_XCC_ID, 0, 4)
  s_or_b32 s35, s35, 16
  s_waitcnt vmcnt(3)
L_m_cen:
  v_readfirstlane_b32 s36, v30
  v_readfirstlane_b32 s37, v31
  s_and_b32 s34, s36, s37
  s_and_b32 s34, s34, 0x10101010
  s_cmp_eq_u32 s34, 0x10101010
  s_cbranch_scc0 L_m_cen2
L_m_cenok:
  s_lshl_b32 s34, s92, 3
  s_lshr_b64 s[36:37], s[36:37], s34
  s_and_b32 s36, s36, 0xff
  s_xor_b32 s99, s36, s35
  v_mov_b32 v9, 159748
  v_mov_b32 v10, s99
  ds_write_b32 v9, v10
L_m_cskip:
  s_waitcnt lgkmcnt(0)
  s_barrier
  v_mov_b32 v9, 159748
  ds_read_b32 v9, v9
  s_waitcnt lgkmcnt(0)
  v_readfirstlane_b32 s99, v9
  s_waitcnt vmcnt(7)
  ds_read_b64_tr_b16 v[48:49], v24 offset:0
  ds_read_b64_tr_b16 v[50:51], v24 offset:256
  s_waitcnt vmcnt(6)
  ds_read_b64_tr_b16 v[52:53], v24 offset:4096
  ds_read_b64_tr_b16 v[54:55], v24 offset:4352
  s_waitcnt vmcnt(5)
  ds_read_b64_tr_b16 v[56:57], v24 offset:8192
  ds_read_b64_tr_b16 v[58:59], v24 offset:8448
  s_waitcnt vmcnt(4)
  ds_read_b64_tr_b16 v[60:61], v24 offset:12288
  ds_read_b64_tr_b16 v[62:63], v24 offset:12544
  s_waitcnt vmcnt(2)
  ds_read_b64_tr_b16 v[64:65], v24 offset:16384
  ds_read_b64_tr_b16 v[66:67], v24 offset:16640
  s_waitcnt vmcnt(1)
  ds_read_b64_tr_b16 v[68:69], v24 offset:20480
  ds_read_b64_tr_b16 v[70:71], v24 offset:20736
  s_waitcnt vmcnt(0)
  ds_read_b64_tr_b16 v[72:73], v24 offset:24576
  ds_read_b64_tr_b16 v[74:75], v24 offset:24832
  s_waitcnt lgkmcnt(12)
  v_mfma_f32_16x16x32_bf16 v[44:47], v[32:35], v[48:51], 0
  s_waitcnt lgkmcnt(10)
  v_mfma_f32_16x16x32_bf16 v[44:47], v[32:35], v[52:55], v[44:47]
  s_waitcnt lgkmcnt(8)
  v_mfma_f32_16x16x32_bf16 v[44:47], v[32:35], v[56:59], v[44:47]
  s_waitcnt lgkmcnt(6)
  v_mfma_f32_16x16x32_bf16 v[44:47], v[32:35], v[60:63], v[44:47]
  s_waitcnt lgkmcnt(4)
  v_mfma_f32_16x16x32_bf16 v[44:47], v[32:35], v[64:67], v[44:47]
  s_waitcnt lgkmcnt(2)
  v_mfma_f32_16x16x32_bf16 v[44:47], v[32:35], v[68:71], v[44:47]
  s_waitcnt lgkmcnt(0)
  v_mfma_f32_16x16x32_bf16 v[44:47], v[32:35], v[72:75], v[44:47]
  s_nop 7
  s_nop 1
  s_mov_b64 exec, 0xffff
  ds_add_f32 v25, v44 offset:256
  ds_add_f32 v25, v45 offset:320
  s_mov_b64 exec, -1
  s_waitcnt lgkmcnt(0)
  s_barrier
  v_lshlrev_b32 v5, 7, v1
  v_lshrrev_b32 v10, 3, v1
  v_and_b32 v11, 7, v1
  v_bfe_u32 v6, v1, 4, 1
  v_lshlrev_b32 v6, 2, v6
  v_xor_b32 v11, v11, v6
  v_mul_u32_u24 v6, 896, v10
  v_lshl_add_u32 v6, v11, 4, v6
  v_add_u32 v7, 6144, v6
  v_lshrrev_b32 v10, 2, v1
  v_mul_u32_u24 v8, 3584, v10
  v_and_b32 v11, 3, v1
  v_lshl_add_u32 v8, v11, 4, v8
  v_bfe_u32 v9, v1, 2, 2
  v_lshl_add_u32 v9, v3, 2, v9
  v_lshlrev_b32 v9, 6, v9
  v_bfe_u32 v10, v1, 4, 1
  v_lshl_add_u32 v9, v10, 5, v9
  v_lshl_add_u32 v9, v11, 3, v9
  s_lshl_b32 s48, s29, 12
  v_add_u32 v9, s48, v9
  v_add_u32 v12, 49152, v9
  v_add_u32 v13, 131072, v9
  v_xor_b32 v14, v10, v1
  v_and_b32 v14, 1, v14
  v_cmp_eq_u32 vcc, 0, v14
  v_mov_b32 v14, 0x3f803f80
  v_cndmask_b32 v248, 0, v14, vcc
  v_cndmask_b32 v249, 0, v14, vcc
  v_cndmask_b32 v250, 0, v14, vcc
  v_cndmask_b32 v251, 0, v14, vcc
  s_mov_b32 s32, s12
  s_mov_b32 s33, s13
  s_mov_b32 s34, 0x188000
  s_mov_b32 s35, 0x00020000
  s_lshr_b32 s47, s2, 3
  s_lshl_b32 s30, s29, 5
  s_add_u32 s47, s47, s30
  s_lshl_b32 s47, s47, 13
  s_mov_b32 s16, s8
  s_mov_b32 s17, s9
  s_mov_b32 s18, 0x62000
  s_mov_b32 s19, 0x00020000
  s_mov_b32 s24, s10
  s_mov_b32 s25, s11
  s_mov_b32 s26, 0x188000
  s_mov_b32 s27, 0x00020000
  s_mov_b32 s36, s4
  s_mov_b32 s37, s5
  s_mov_b32 s38, 0x1c0000
  s_mov_b32 s39, 0x00020000
  s_lshl_b32 s42, s97, 8
  s_lshl_b32 s43, s29, 6
  s_add_u32 s42, s42, s43
  s_add_u32 s40, s48, 49152
  s_mov_b32 m0, s40
  s_add_u32 s41, s42, 0
  buffer_load_dwordx4 v8, s[24:27], s41 offen lds
  s_add_u32 s40, s48, 50176
  s_mov_b32 m0, s40
  s_add_u32 s41, s42, 57344
  buffer_load_dwordx4 v8, s[24:27], s41 offen lds
  s_add_u32 s40, s48, 51200
  s_mov_b32 m0, s40
  s_add_u32 s41, s42, 114688
  buffer_load_dwordx4 v8, s[24:27], s41 offen lds
  s_add_u32 s40, s48, 52224
  s_mov_b32 m0, s40
  s_add_u32 s41, s42, 172032
  buffer_load_dwordx4 v8, s[24:27], s41 offen lds
  s_barrier
  s_cmp_lg_u32 s101, 0
  s_cbranch_scc1 L_m_lnon
  s_waitcnt vmcnt(2)
  ds_read_b64_tr_b16 v[16:17], v12 offset:0
  ds_read_b64_tr_b16 v[18:19], v12 offset:512
  ds_read_b64_tr_b16 v[20:21], v12 offset:1024
  ds_read_b64_tr_b16 v[22:23], v12 offset:1536
  s_add_u32 s40, s48, 131072
  s_mov_b32 m0, s40
  s_add_u32 s41, s42, 229376
  buffer_load_dwordx4 v8, s[24:27], s41 offen lds
  s_add_u32 s40, s48, 132096
  s_mov_b32 m0, s40
  s_add_u32 s41, s42, 286720
  buffer_load_dwordx4 v8, s[24:27], s41 offen lds
  s_waitcnt lgkmcnt(0)
  v_mfma_f32_16x16x32_bf16 v[252:255], v[248:251], v[16:19], 0
  v_mfma_f32_16x16x32_bf16 v[252:255], v[248:251], v[20:23], v[252:255]
  s_waitcnt vmcnt(2)
  ds_read_b64_tr_b16 v[24:25], v12 offset:2048
  ds_read_b64_tr_b16 v[26:27], v12 offset:2560
  ds_read_b64_tr_b16 v[28:29], v12 offset:3072
  ds_read_b64_tr_b16 v[30:31], v12 offset:3584
  s_add_u32 s40, s48, 133120
  s_mov_b32 m0, s40
  s_add_u32 s41, s42, 344064
  buffer_load_dwordx4 v8, s[24:27], s41 offen lds
  s_add_u32 s40, s48, 134144
  s_mov_b32 m0, s40
  s_add_u32 s41, s42, 401408
  buffer_load_dwordx4 v8, s[24:27], s41 offen lds
  s_waitcnt lgkmcnt(0)
  v_mfma_f32_16x16x32_bf16 v[252:255], v[248:251], v[24:27], v[252:255]
  v_mfma_f32_16x16x32_bf16 v[252:255], v[248:251], v[28:31], v[252:255]
  s_waitcnt vmcnt(2)
  ds_read_b64_tr_b16 v[32:33], v13 offset:0
  ds_read_b64_tr_b16 v[34:35], v13 offset:512
  ds_read_b64_tr_b16 v[36:37], v13 offset:1024
  ds_read_b64_tr_b16 v[38:39], v13 offset:1536
  s_add_u32 s40, s48, 49152
  s_mov_b32 m0, s40
  s_add_u32 s41, s42, 458752
  buffer_load_dwordx4 v8, s[24:27], s41 offen lds
  s_add_u32 s40, s48, 50176
  s_mov_b32 m0, s40
  s_add_u32 s41, s42, 516096
  buffer_load_dwordx4 v8, s[24:27], s41 offen lds
  s_waitcnt lgkmcnt(0)
  v_mfma_f32_16x16x32_bf16 v[252:255], v[248:251], v[32:35], v[252:255]
  v_mfma_f32_16x16x32_bf16 v[252:255], v[248:251], v[36:39], v[252:255]
  s_waitcnt vmcnt(2)
  ds_read_b64_tr_b16 v[40:41], v13 offset:2048
  ds_read_b64_tr_b16 v[42:43], v13 offset:2560
  ds_read_b64_tr_b16 v[44:45], v13 offset:3072
  ds_read_b64_tr_b16 v[46:47], v13 offset:3584
  s_add_u32 s40, s48, 51200
  s_mov_b32 m0, s40
  s_add_u32 s41, s42, 573440
  buffer_load_dwordx4 v8, s[24:27], s41 offen lds
  s_add_u32 s40, s48, 52224
  s_mov_b32 m0, s40
  s_add_u32 s41, s42, 630784
  buffer_load_dwordx4 v8, s[24:27], s41 offen lds
  s_waitcnt lgkmcnt(0)
  v_mfma_f32_16x16x32_bf16 v[252:255], v[248:251], v[40:43], v[252:255]
  v_mfma_f32_16x16x32_bf16 v[252:255], v[248:251], v[44:47], v[252:255]
  s_waitcnt vmcnt(2)
  ds_read_b64_tr_b16 v[48:49], v12 offset:0
  ds_read_b64_tr_b16 v[50:51], v12 offset:512
  ds_read_b64_tr_b16 v[52:53], v12 offset:1024
  ds_read_b64_tr_b16 v[54:55], v12 offset:1536
  s_add_u32 s40, s48, 131072
  s_mov_b32 m0, s40
  s_add_u32 s41, s42, 688128
  buffer_load_dwordx4 v8, s[24:27], s41 offen lds
  s_add_u32 s40, s48, 132096
  s_mov_b32 m0, s40
  s_add_u32 s41, s42, 745472
  buffer_load_dwordx4 v8, s[24:27], s41 offen lds
  s_waitcnt lgkmcnt(0)
  v_mfma_f32_16x16x32_bf16 v[252:255], v[248:251], v[48:51], v[252:255]
  v_mfma_f32_16x16x32_bf16 v[252:255], v[248:251], v[52:55], v[252:255]
  s_waitcnt vmcnt(2)
  ds_read_b64_tr_b16 v[56:57], v12 offset:2048
  ds_read_b64_tr_b16 v[58:59], v12 offset:2560
  ds_read_b64_tr_b16 v[60:61], v12 offset:3072
  ds_read_b64_tr_b16 v[62:63], v12 offset:3584
  s_add_u32 s40, s48, 133120
  s_mov_b32 m0, s40
  s_add_u32 s41, s42, 802816
  buffer_load_dwordx4 v8, s[24:27], s41 offen lds
  s_add_u32 s40, s48, 134144
  s_mov_b32 m0, s40
  s_add_u32 s41, s42, 860160
  buffer_load_dwordx4 v8, s[24:27], s41 offen lds
  s_waitcnt lgkmcnt(0)
  v_mfma_f32_16x16x32_bf16 v[252:255], v[248:251], v[56:59], v[252:255]
  v_mfma_f32_16x16x32_bf16 v[252:255], v[248:251], v[60:63], v[252:255]
  s_waitcnt vmcnt(2)
  ds_read_b64_tr_b16 v[64:65], v13 offset:0
  ds_read_b64_tr_b16 v[66:67], v13 offset:512
  ds_read_b64_tr_b16 v[68:69], v13 offset:1024
  ds_read_b64_tr_b16 v[70:71], v13 offset:1536
  s_add_u32 s40, s48, 49152
  s_mov_b32 m0, s40
  s_add_u32 s41, s42, 917504
  buffer_load_dwordx4 v8, s[24:27], s41 offen lds
  s_add_u32 s40, s48, 50176
  s_mov_b32 m0, s40
  s_add_u32 s41, s42, 974848
  buffer_load_dwordx4 v8, s[24:27], s41 offen lds
  s_waitcnt lgkmcnt(0)
  v_mfma_f32_16x16x32_bf16 v[252:255], v[248:251], v[64:67], v[252:255]
  v_mfma_f32_16x16x32_bf16 v[252:255], v[248:251], v[68:71], v[252:255]
  s_waitcnt vmcnt(2)
  ds_read_b64_tr_b16 v[72:73], v13 offset:2048
  ds_read_b64_tr_b16 v[74:75], v13 offset:2560
  ds_read_b64_tr_b16 v[76:77], v13 offset:3072
  ds_read_b64_tr_b16 v[78:79], v13 offset:3584
  s_add_u32 s40, s48, 51200
  s_mov_b32 m0, s40
  s_add_u32 s41, s42, 1032192
  buffer_load_dwordx4 v8, s[24:27], s41 offen lds
  s_add_u32 s40, s48, 52224
  s_mov_b32 m0, s40
  s_add_u32 s41, s42, 1089536
  buffer_load_dwordx4 v8, s[24:27], s41 offen lds
  s_waitcnt lgkmcnt(0)
  v_mfma_f32_16x16x32_bf16 v[252:255], v[248:251], v[72:75], v[252:255]
  v_mfma_f32_16x16x32_bf16 v[252:255], v[248:251], v[76:79], v[252:255]
  s_waitcnt vmcnt(2)
  ds_read_b64_tr_b16 v[80:81], v12 offset:0
  ds_read_b64_tr_b16 v[82:83], v12 offset:512
  ds_read_b64_tr_b16 v[84:85], v12 offset:1024
  ds_read_b64_tr_b16 v[86:87], v12 offset:1536
  s_add_u32 s40, s48, 131072
  s_mov_b32 m0, s40
  s_add_u32 s41, s42, 1146880
  buffer_load_dwordx4 v8, s[24:27], s41 offen lds
  s_add_u32 s40, s48, 132096
  s_mov_b32 m0, s40
  s_add_u32 s41, s42, 1204224
  buffer_load_dwordx4 v8, s[24:27], s41 offen lds
  s_waitcnt lgkmcnt(0)
  v_mfma_f32_16x16x32_bf16 v[252:255], v[248:251], v[80:83], v[252:255]
  v_mfma_f32_16x16x32_bf16 v[252:255], v[248:251], v[84:87], v[252:255]
  s_waitcnt vmcnt(2)
  ds_read_b64_tr_b16 v[88:89], v12 offset:2048
  ds_read_b64_tr_b16 v[90:91], v12 offset:2560
  ds_read_b64_tr_b16 v[92:93], v12 offset:3072
  ds_read_b64_tr_b16 v[94:95], v12 offset:3584
  s_add_u32 s40, s48, 133120
  s_mov_b32 m0, s40
  s_add_u32 s41, s42, 1261568
  buffer_load_dwordx4 v8, s[24:27], s41 offen lds
  s_add_u32 s40, s48, 134144
  s_mov_b32 m0, s40
  s_add_u32 s41, s42, 1318912
  buffer_load_dwordx4 v8, s[24:27], s41 offen lds
  s_waitcnt lgkmcnt(0)
  v_mfma_f32_16x16x32_bf16 v[252:255], v[248:251], v[88:91], v[252:255]
  v_mfma_f32_16x16x32_bf16 v[252:255], v[248:251], v[92:95], v[252:255]
  s_waitcnt vmcnt(2)
  ds_read_b64_tr_b16 v[96:97], v13 offset:0
  ds_read_b64_tr_b16 v[98:99], v13 offset:512
  ds_read_b64_tr_b16 v[100:101], v13 offset:1024
  ds_read_b64_tr_b16 v[102:103], v13 offset:1536
  s_add_u32 s40, s48, 49152
  s_mov_b32 m0, s40
  s_add_u32 s41, s42, 1376256
  buffer_load_dwordx4 v8, s[24:27], s41 offen lds
  s_add_u32 s40, s48, 50176
  s_mov_b32 m0, s40
  s_add_u32 s41, s42, 1433600
  buffer_load_dwordx4 v8, s[24:27], s41 offen lds
  s_waitcnt lgkmcnt(0)
  v_mfma_f32_16x16x32_bf16 v[252:255], v[248:251], v[96:99], v[252:255]
  v_mfma_f32_16x16x32_bf16 v[252:255], v[248:251], v[100:103], v[252:255]
  s_waitcnt vmcnt(2)
  ds_read_b64_tr_b16 v[104:105], v13 offset:2048
  ds_read_b64_tr_b16 v[106:107], v13 offset:2560
  ds_read_b64_tr_b16 v[108:109], v13 offset:3072
  ds_read_b64_tr_b16 v[110:111], v13 offset:3584
  s_add_u32 s40, s48, 51200
  s_mov_b32 m0, s40
  s_add_u32 s41, s42, 1490944
  buffer_load_dwordx4 v8, s[24:27], s41 offen lds
  s_add_u32 s40, s48, 52224
  s_mov_b32 m0, s40
  s_add_u32 s41, s42, 1548288
  buffer_load_dwordx4 v8, s[24:27], s41 offen lds
  s_waitcnt lgkmcnt(0)
  v_mfma_f32_16x16x32_bf16 v[252:255], v[248:251], v[104:107], v[252:255]
  v_mfma_f32_16x16x32_bf16 v[252:255], v[248:251], v[108:111], v[252:255]
  s_waitcnt vmcnt(2)
  ds_read_b64_tr_b16 v[112:113], v12 offset:0
  ds_read_b64_tr_b16 v[114:115], v12 offset:512
  ds_read_b64_tr_b16 v[116:117], v12 offset:1024
  ds_read_b64_tr_b16 v[118:119], v12 offset:1536
  s_waitcnt lgkmcnt(0)
  v_mfma_f32_16x16x32_bf16 v[252:255], v[248:251], v[112:115], v[252:255]
  v_mfma_f32_16x16x32_bf16 v[252:255], v[248:251], v[116:119], v[252:255]
  s_waitcnt vmcnt(0)
  ds_read_b64_tr_b16 v[120:121], v12 offset:2048
  ds_read_b64_tr_b16 v[122:123], v12 offset:2560
  ds_read_b64_tr_b16 v[124:125], v12 offset:3072
  ds_read_b64_tr_b16 v[126:127], v12 offset:3584
  s_waitcnt lgkmcnt(0)
  v_mfma_f32_16x16x32_bf16 v[252:255], v[248:251], v[120:123], v[252:255]
  v_mfma_f32_16x16x32_bf16 v[252:255], v[248:251], v[124:127], v[252:255]
  s_mul_i32 s30, s29, 100352
  s_lshl_b32 s31, s96, 7
  s_add_u32 s30, s30, s31
  s_lshl_b32 s31, s29, 14
  s_add_u32 s31, s31, 65536
  s_add_u32 s40, s31, 0
  s_mov_b32 m0, s40
  s_add_u32 s41, s30, 0
  buffer_load_dwordx4 v6, s[16:19], s41 offen lds
  buffer_load_dwordx4 v7, s[16:19], s41 offen offset:1024 lds
  s_waitcnt vmcnt(4)
  s_add_u32 s40, s31, 2048
  s_mov_b32 m0, s40
  s_add_u32 s41, s30, 14336
  buffer_load_dwordx4 v6, s[16:19], s41 offen lds
  buffer_load_dwordx4 v7, s[16:19], s41 offen offset:1024 lds
  s_waitcnt vmcnt(4)
  s_add_u32 s40, s31, 4096
  s_mov_b32 m0, s40
  s_add_u32 s41, s30, 25088
  buffer_load_dwordx4 v6, s[16:19], s41 offen lds
  buffer_load_dwordx4 v7, s[16:19], s41 offen offset:1024 lds
  s_waitcnt vmcnt(4)
  s_add_u32 s40, s31, 6144
  s_mov_b32 m0, s40
  s_add_u32 s41, s30, 39424
  buffer_load_dwordx4 v6, s[16:19], s41 offen lds
  buffer_load_dwordx4 v7, s[16:19], s41 offen offset:1024 lds
  s_waitcnt vmcnt(4)
  s_add_u32 s40, s31, 8192
  s_mov_b32 m0, s40
  s_add_u32 s41, s30, 50176
  buffer_load_dwordx4 v6, s[16:19], s41 offen lds
  buffer_load_dwordx4 v7, s[16:19], s41 offen offset:1024 lds
  s_waitcnt vmcnt(4)
  s_add_u32 s40, s31, 10240
  s_mov_b32 m0, s40
  s_add_u32 s41, s30, 64512
  buffer_load_dwordx4 v6, s[16:19], s41 offen lds
  buffer_load_dwordx4 v7, s[16:19], s41 offen offset:1024 lds
  s_waitcnt vmcnt(4)
  s_add_u32 s40, s31, 12288
  s_mov_b32 m0, s40
  s_add_u32 s41, s30, 75264
  buffer_load_dwordx4 v6, s[16:19], s41 offen lds
  buffer_load_dwordx4 v7, s[16:19], s41 offen offset:1024 lds
  s_waitcnt vmcnt(4)
  s_add_u32 s40, s31, 14336
  s_mov_b32 m0, s40
  s_add_u32 s41, s30, 89600
  buffer_load_dwordx4 v6, s[16:19], s41 offen lds
  buffer_load_dwordx4 v7, s[16:19], s41 offen offset:1024 lds
  s_lshl_b32 s30, s29, 7
  s_add_u32 s30, s30, 162816
  v_and_b32 v10, 15, v1
  v_lshl_add_u32 v10, v10, 2, s30
  ds_write2_b32 v10, v252, v253 offset1:16
  v_lshl_add_u32 v10, v2, 2, s30
  s_waitcnt lgkmcnt(0)
  ds_read_b32 v200, v10
  v_mov_b32 v193, 0
  v_mov_b32 v194, 0
  v_mov_b32 v195, 0
  v_mov_b32 v196, 0
  v_mov_b32 v197, 0
  v_mov_b32 v198, 0
  v_mov_b32 v199, 0
  s_waitcnt lgkmcnt(0)
  v_cvt_pk_bf16_f32 v201, v200, v200
  v_lshlrev_b32 v201, 16, v201
  v_sub_f32 v200, v200, v201
  v_cvt_pk_bf16_f32 v202, v200, v200
  v_lshlrev_b32 v202, 16, v202
  v_sub_f32 v200, v200, v202
  v_cvt_pk_bf16_f32 v201, v201, v202
  v_cvt_pk_bf16_f32 v200, v200, 0
  v_cmp_eq_u32 vcc, 0, v3
  v_cndmask_b32 v192, v200, v201, vcc
  v_mov_b32 v201, 0
  v_mov_b32 v202, 0
  v_mov_b32 v203, 0
  s_waitcnt vmcnt(0)
  buffer_load_dword v225, v5, s[32:35], s47 offen
  s_add_u32 s47, s47, 1048576
  s_waitcnt vmcnt(0)
  buffer_load_dword v226, v5, s[32:35], s47 offen
  s_add_u32 s47, s47, 1048576
  v_and_b32 v11, 15, v1
  v_lshlrev_b32 v10, 7, v11
  s_lshl_b32 s40, s97, 2
  s_add_u32 s40, s40, s29
  s_lshl_b32 s40, s40, 11
  s_mul_i32 s41, s94, 114688
  s_add_u32 s40, s40, s41
  s_add_u32 s40, s40, 0x600000
  buffer_load_dword v229, v10, s[20:23], s40 offen
  s_lshl_b32 s40, s94, 2
  s_lshl_b32 s41, s95, 1
  s_add_u32 s40, s40, s41
  s_and_b32 s41, s29, 1
  s_add_u32 s40, s40, s41
  s_lshl_b32 s41, s96, 1
  s_lshr_b32 s43, s29, 1
  s_add_u32 s41, s41, s43
  s_mul_i32 s44, s40, 28672
  s_lshl_b32 s43, s41, 11
  s_add_u32 s43, s43, s44
  s_mov_b32 s52, s14
  s_mov_b32 s53, s15
  s_mov_b32 s54, 0x1c0000
  s_mov_b32 s55, 0x00020000
  buffer_load_dword v230, v10, s[52:55], s43 offen
  v_and_b32 v10, 128, v10
  s_mul_i32 s43, s40, 3584
  s_lshl_b32 s44, s41, 8
  s_add_u32 s43, s43, s44
  s_add_u32 s43, s43, 0x7c0000
  buffer_load_dword v231, v10, s[20:23], s43 offen
  v_mul_u32_u24 v10, 896, v1
  s_lshl_b32 s40, s94, 1
  s_add_u32 s40, s40, s95
  s_mul_i32 s40, s40, 57344
  s_lshl_b32 s41, s96, 7
  s_add_u32 s40, s40, s41
  s_cmp_lg_u32 s29, 3
  s_cbranch_scc1 L_m_nox
  buffer_load_dword v228, v10, s[36:39], s40 offen
L_m_nox:
  s_mul_i32 s44, s29, 28672
  s_lshl_b32 s45, s96, 7
  s_add_u32 s44, s44, s45
  s_mul_i32 s45, s95, 114688
  s_add_u32 s45, s45, s44
  s_add_u32 s46, s48, 147456
  s_cmp_eq_u32 s29, 3
  s_cselect_b32 s46, 126976, s46
  s_add_u32 s40, s48, 49152
  s_mov_b32 m0, s40
  s_add_u32 s41, s45, 0
  buffer_load_dwordx4 v6, s[32:35], s41 offen lds
  buffer_load_dwordx4 v7, s[32:35], s41 offen offset:1024 lds
  s_add_u32 s40, s48, 51200
  s_mov_b32 m0, s40
  s_add_u32 s41, s45, 14336
  buffer_load_dwordx4 v6, s[32:35], s41 offen lds
  buffer_load_dwordx4 v7, s[32:35], s41 offen offset:1024 lds
  s_add_u32 s40, s48, 131072
  s_mov_b32 m0, s40
  s_add_u32 s41, s45, 229376
  buffer_load_dwordx4 v6, s[32:35], s41 offen lds
  buffer_load_dwordx4 v7, s[32:35], s41 offen offset:1024 lds
  s_add_u32 s40, s48, 133120
  s_mov_b32 m0, s40
  s_add_u32 s41, s45, 243712
  buffer_load_dwordx4 v6, s[32:35], s41 offen lds
  buffer_load_dwordx4 v7, s[32:35], s41 offen offset:1024 lds
  s_lshl_b32 s50, s95, 1
  s_and_b32 s51, s96, 1
  s_add_u32 s50, s50, s51
  s_mul_i32 s51, s94, 114688
  s_lshl_b32 s49, s29, 10
  s_add_u32 s51, s51, s49
  s_xor_b32 s40, s50, 0
  s_mul_i32 s52, s40, 28672
  s_add_u32 s52, s52, s51
  s_xor_b32 s40, s50, 1
  s_mul_i32 s53, s40, 28672
  s_add_u32 s53, s53, s51
  s_xor_b32 s40, s50, 2
  s_mul_i32 s54, s40, 28672
  s_add_u32 s54, s54, s51
  s_xor_b32 s40, s50, 3
  s_mul_i32 s55, s40, 28672
  s_add_u32 s55, s55, s51
L_m_follow:
  s_barrier
  s_barrier
  v_mov_b32 v10, 159744
  ds_read_b64 v[10:11], v10
  s_waitcnt lgkmcnt(0)
  v_readfirstlane_b32 s30, v10
  v_readfirstlane_b32 s99, v11
  s_nop 3
  s_andn2_b32 s30, s30, s60
  s_cmp_eq_u32 s30, 0
  s_cbranch_scc1 L_m_lgo
  s_mov_b32 s60, 1
  s_barrier
  s_barrier
  s_branch L_m_follow
L_m_lgo:
  s_add_u32 s40, s48, 0
  s_mov_b32 m0, s40
  s_add_u32 s41, s45, 458752
  buffer_load_dwordx4 v6, s[32:35], s41 offen lds
  buffer_load_dwordx4 v7, s[32:35], s41 offen offset:1024 lds
  s_add_u32 s40, s48, 2048
  s_mov_b32 m0, s40
  s_add_u32 s41, s45, 473088
  buffer_load_dwordx4 v6, s[32:35], s41 offen lds
  buffer_load_dwordx4 v7, s[32:35], s41 offen offset:1024 lds
  s_add_u32 s40, s48, 16384
  s_mov_b32 m0, s40
  s_add_u32 s41, s45, 688128
  buffer_load_dwordx4 v6, s[32:35], s41 offen lds
  buffer_load_dwordx4 v7, s[32:35], s41 offen offset:1024 lds
  s_add_u32 s40, s48, 18432
  s_mov_b32 m0, s40
  s_add_u32 s41, s45, 702464
  buffer_load_dwordx4 v6, s[32:35], s41 offen lds
  buffer_load_dwordx4 v7, s[32:35], s41 offen offset:1024 lds
  s_add_u32 s40, s48, 32768
  s_mov_b32 m0, s40
  s_add_u32 s41, s45, 917504
  buffer_load_dwordx4 v6, s[32:35], s41 offen lds
  buffer_load_dwordx4 v7, s[32:35], s41 offen offset:1024 lds
  s_add_u32 s40, s48, 34816
  s_mov_b32 m0, s40
  s_add_u32 s41, s45, 931840
  buffer_load_dwordx4 v6, s[32:35], s41 offen lds
  buffer_load_dwordx4 v7, s[32:35], s41 offen offset:1024 lds
  s_add_u32 s40, s48, 110592
  s_mov_b32 m0, s40
  s_add_u32 s41, s45, 1146880
  buffer_load_dwordx4 v6, s[32:35], s41 offen lds
  buffer_load_dwordx4 v7, s[32:35], s41 offen offset:1024 lds
  s_add_u32 s40, s48, 112640
  s_mov_b32 m0, s40
  s_add_u32 s41, s45, 1161216
  buffer_load_dwordx4 v6, s[32:35], s41 offen lds
  buffer_load_dwordx4 v7, s[32:35], s41 offen offset:1024 lds
  s_add_u32 s40, s46, 0
  s_mov_b32 m0, s40
  s_add_u32 s41, s45, 1376256
  buffer_load_dwordx4 v6, s[32:35], s41 offen lds
  buffer_load_dwordx4 v7, s[32:35], s41 offen offset:1024 lds
  s_add_u32 s40, s46, 2048
  s_mov_b32 m0, s40
  s_add_u32 s41, s45, 1390592
  buffer_load_dwordx4 v6, s[32:35], s41 offen lds
  buffer_load_dwordx4 v7, s[32:35], s41 offen offset:1024 lds
  s_lshl_b32 s35, s97, 2
  s_add_u32 s35, s35, s29
  s_lshl_b32 s35, s35, 11
  s_lshl_b32 s56, s94, 18
  s_add_u32 s56, s56, 0x200000
  s_add_u32 s57, s56, 114688
  s_lshl_b32 s58, s94, 17
  s_mul_i32 s59, s94, 114688
  s_add_u32 s59, s59, 0x600000
  s_mov_b32 s16, s14
  s_mov_b32 s17, s15
  s_mov_b32 s18, 0x1c0000
  s_mov_b32 s19, 0x00020000
  s_xor_b32 s33, s50, 0
  s_mov_b32 s36, s56
  s_cmp_eq_u32 s33, 1
  s_cselect_b32 s36, s57, s36
  s_cmp_eq_u32 s33, 2
  s_cselect_b32 s36, s58, s36
  s_cmp_eq_u32 s33, 3
  s_cselect_b32 s36, s59, s36
  s_add_u32 s36, s36, s35
  s_lshl_b32 s42, s33, 9
  s_xor_b32 s33, s50, 1
  s_mov_b32 s37, s56
  s_cmp_eq_u32 s33, 1
  s_cselect_b32 s37, s57, s37
  s_cmp_eq_u32 s33, 2
  s_cselect_b32 s37, s58, s37
  s_cmp_eq_u32 s33, 3
  s_cselect_b32 s37, s59, s37
  s_add_u32 s37, s37, s35
  s_lshl_b32 s43, s33, 9
  s_xor_b32 s33, s50, 2
  s_mov_b32 s38, s56
  s_cmp_eq_u32 s33, 1
  s_cselect_b32 s38, s57, s38
  s_cmp_eq_u32 s33, 2
  s_cselect_b32 s38, s58, s38
  s_cmp_eq_u32 s33, 3
  s_cselect_b32 s38, s59, s38
  s_add_u32 s38, s38, s35
  s_lshl_b32 s44, s33, 9
  s_xor_b32 s33, s50, 3
  s_mov_b32 s39, s56
  s_cmp_eq_u32 s33, 1
  s_cselect_b32 s39, s57, s39
  s_cmp_eq_u32 s33, 2
  s_cselect_b32 s39, s58, s39
  s_cmp_eq_u32 s33, 3
  s_cselect_b32 s39, s59, s39
  s_add_u32 s39, s39, s35
  s_lshl_b32 s45, s33, 9
  s_lshl_b32 s33, s94, 2
  s_add_u32 s33, s33, s29
  s_mul_i32 s47, s33, 3584
  s_add_u32 s47, s47, 0x7c0000
  v_lshlrev_b32 v8, 3, v2
  v_mul_u32_u24 v9, 1792, v3
  v_add_u32 v8, v8, v9
  v_add_u32 v12, 65536, v4
  v_add_u32 v13, 131072, v4
  v_lshlrev_b32 v11, 3, v2
  v_add_u32 v11, 160768, v11
  s_lshl_b32 s33, s29, 9
  v_add_u32 v9, s33, v11
  s_lshl_b32 s33, s97, 4
  s_lshl_b32 s34, s29, 2
  s_add_u32 s33, s33, s34
  v_mov_b32 v15, s33
  s_mov_b32 s33, 0x3b124925
  s_mov_b32 s34, 0xbfb8aa3b
  v_min_u32 v10, 55, v1
  v_lshlrev_b32 v10, 2, v10
  s_waitcnt vmcnt(0)
  s_barrier
  s_setprio 2
  s_lshl_b32 s56, s94, 10
  s_add_u32 s56, s56, 0x7f8200
  v_lshlrev_b32 v5, 2, v1
L_poll_71:
  buffer_load_dword v6, v5, s[20:23], s56 offen sc1
  s_waitcnt vmcnt(0)
  v_and_b32 v7, 0xff, v6
  v_cmp_le_u32 vcc, 1, v7
  s_cmp_eq_u64 vcc, exec
  s_cbranch_scc1 L_pd_72
  s_sub_u32 s100, s100, 1
  s_cbranch_scc0 L_poll_71
  s_mov_b32 s100, 0
L_pd_72:
  s_barrier
L_poll_73:
  buffer_load_dword v6, v10, s[20:23], s98 offen sc1
  s_waitcnt vmcnt(0)
  v_and_b32 v7, 0xff, v6
  v_cmp_le_u32 vcc, 1, v7
  s_cmp_eq_u64 vcc, exec
  s_cbranch_scc1 L_pd_74
  s_sub_u32 s100, s100, 1
  s_cbranch_scc0 L_poll_73
  s_mov_b32 s100, 0
L_pd_74:
  s_cmp_eq_u32 s99, 0
  s_cbranch_scc1 L_aq_75
  buffer_inv sc1
  s_waitcnt vmcnt(0)
L_aq_75:
  s_add_u32 s40, s49, 65536
  s_mov_b32 m0, s40
  s_add_u32 s41, s52, 0
  buffer_load_dwordx4 v4, s[16:19], s41 offen sc1 lds
  s_add_u32 s40, s49, 69632
  s_mov_b32 m0, s40
  s_add_u32 s41, s52, 4096
  buffer_load_dwordx4 v4, s[16:19], s41 offen sc1 lds
  s_add_u32 s40, s49, 73728
  s_mov_b32 m0, s40
  s_add_u32 s41, s52, 8192
  buffer_load_dwordx4 v4, s[16:19], s41 offen sc1 lds
  s_add_u32 s40, s49, 77824
  s_mov_b32 m0, s40
  s_add_u32 s41, s52, 12288
  buffer_load_dwordx4 v4, s[16:19], s41 offen sc1 lds
  s_add_u32 s40, s49, 81920
  s_mov_b32 m0, s40
  s_add_u32 s41, s52, 16384
  buffer_load_dwordx4 v4, s[16:19], s41 offen sc1 lds
  s_add_u32 s40, s49, 86016
  s_mov_b32 m0, s40
  s_add_u32 s41, s52, 20480
  buffer_load_dwordx4 v4, s[16:19], s41 offen sc1 lds
  s_add_u32 s40, s49, 90112
  s_mov_b32 m0, s40
  s_add_u32 s41, s52, 24576
  buffer_load_dwordx4 v4, s[16:19], s41 offen sc1 lds
  buffer_load_dwordx2 v[224:225], v8, s[20:23], s47 offen offset:0 sc1
  buffer_load_dwordx2 v[226:227], v8, s[20:23], s47 offen offset:256 sc1
  buffer_load_dwordx2 v[228:229], v8, s[20:23], s47 offen offset:512 sc1
  buffer_load_dwordx2 v[230:231], v8, s[20:23], s47 offen offset:768 sc1
  buffer_load_dwordx2 v[232:233], v8, s[20:23], s47 offen offset:1024 sc1
  buffer_load_dwordx2 v[234:235], v8, s[20:23], s47 offen offset:1280 sc1
  buffer_load_dwordx2 v[236:237], v8, s[20:23], s47 offen offset:1536 sc1
  s_barrier
  s_waitcnt vmcnt(11)
  s_barrier
  ds_read_b128 v[160:163], v12 offset:0
  ds_read_b128 v[164:167], v12 offset:1024
  ds_read_b128 v[168:171], v12 offset:2048
  ds_read_b128 v[172:175], v12 offset:3072
  ds_read_b128 v[176:179], v12 offset:4096
  ds_read_b128 v[180:183], v12 offset:5120
  ds_read_b128 v[184:187], v12 offset:6144
  s_waitcnt lgkmcnt(5)
  v_mfma_f32_32x32x16_bf16 v[128:143], v[16:19], v[160:163], 0
  ds_read_b128 v[188:191], v12 offset:7168
  v_mfma_f32_32x32x16_bf16 v[128:143], v[20:23], v[164:167], v[128:143]
  ds_read_b128 v[160:163], v12 offset:8192
  s_waitcnt lgkmcnt(5)
  v_mfma_f32_32x32x16_bf16 v[128:143], v[24:27], v[168:171], v[128:143]
  ds_read_b128 v[164:167], v12 offset:9216
  v_mfma_f32_32x32x16_bf16 v[128:143], v[28:31], v[172:175], v[128:143]
  ds_read_b128 v[168:171], v12 offset:10240
  s_waitcnt lgkmcnt(5)
  v_mfma_f32_32x32x16_bf16 v[128:143], v[32:35], v[176:179], v[128:143]
  ds_read_b128 v[172:175], v12 offset:11264
  v_mfma_f32_32x32x16_bf16 v[128:143], v[36:39], v[180:183], v[128:143]
  s_waitcnt vmcnt(0)
  s_barrier
  ds_read_b128 v[176:179], v12 offset:12288
  s_waitcnt lgkmcnt(5)
  v_mfma_f32_32x32x16_bf16 v[128:143], v[40:43], v[184:187], v[128:143]
  ds_read_b128 v[180:183], v12 offset:13312
  v_mfma_f32_32x32x16_bf16 v[128:143], v[44:47], v[188:191], v[128:143]
  ds_read_b128 v[184:187], v12 offset:14336
  s_waitcnt lgkmcnt(5)
  v_mfma_f32_32x32x16_bf16 v[128:143], v[48:51], v[160:163], v[128:143]
  v_add_f32 v224, v224, v226
  v_add_f32 v225, v225, v227
  v_add_f32 v224, v224, v228
  ds_read_b128 v[188:191], v12 offset:15360
  v_mfma_f32_32x32x16_bf16 v[128:143], v[52:55], v[164:167], v[128:143]
  v_add_f32 v225, v225, v229
  v_add_f32 v224, v224, v230
  v_add_f32 v225, v225, v231
  ds_read_b128 v[160:163], v12 offset:16384
  s_waitcnt lgkmcnt(5)
  v_mfma_f32_32x32x16_bf16 v[128:143], v[56:59], v[168:171], v[128:143]
  v_add_f32 v224, v224, v232
  v_add_f32 v225, v225, v233
  v_add_f32 v224, v224, v234
  v_add_f32 v225, v225, v235
  ds_read_b128 v[164:167], v12 offset:17408
  v_mfma_f32_32x32x16_bf16 v[128:143], v[60:63], v[172:175], v[128:143]
  v_add_f32 v224, v224, v236
  v_add_f32 v225, v225, v237
  v_mov_b32 v240, v224
  ds_read_b128 v[168:171], v12 offset:18432
  s_waitcnt lgkmcnt(5)
  v_mfma_f32_32x32x16_bf16 v[128:143], v[64:67], v[176:179], v[128:143]
  s_nop 1
  v_permlane32_swap_b32 v240, v224
  s_nop 1
  ds_read_b128 v[172:175], v12 offset:19456
  v_mfma_f32_32x32x16_bf16 v[128:143], v[68:71], v[180:183], v[128:143]
  v_add_f32 v224, v224, v240
  v_mov_b32 v240, v225
  s_nop 1
  ds_read_b128 v[176:179], v12 offset:20480
  s_waitcnt lgkmcnt(5)
  v_mfma_f32_32x32x16_bf16 v[128:143], v[72:75], v[184:187], v[128:143]
  v_permlane32_swap_b32 v240, v225
  s_nop 1
  v_add_f32 v225, v225, v240
  v_mul_f32 v228, s33, v224
  ds_read_b128 v[180:183], v12 offset:21504
  v_mfma_f32_32x32x16_bf16 v[128:143], v[76:79], v[188:191], v[128:143]
  v_mul_f32 v230, s33, v225
  v_fma_f32 v230, -v228, v228, v230
  v_max_f32 v230, 0, v230
  ds_read_b128 v[184:187], v12 offset:22528
  s_waitcnt lgkmcnt(5)
  v_mfma_f32_32x32x16_bf16 v[128:143], v[80:83], v[160:163], v[128:143]
  v_cvt_pk_bf16_f32 v228, -v228, -v228
  v_cvt_pk_bf16_f32 v240, v230, v230
  v_lshlrev_b32 v230, 16, v240
  ds_read_b128 v[188:191], v12 offset:23552
  v_mfma_f32_32x32x16_bf16 v[128:143], v[84:87], v[164:167], v[128:143]
  v_add_f32 v230, 0x3727c5ac, v230
  v_cvt_pk_bf16_f32 v240, v230, v230
  v_lshlrev_b32 v230, 16, v240
  ds_read_b128 v[160:163], v12 offset:24576
  s_waitcnt lgkmcnt(5)
  v_mfma_f32_32x32x16_bf16 v[128:143], v[88:91], v[168:171], v[128:143]
  v_sqrt_f32 v230, v230
  s_nop 0
  v_cvt_pk_bf16_f32 v240, v230, v230
  ds_read_b128 v[164:167], v12 offset:25600
  v_mfma_f32_32x32x16_bf16 v[128:143], v[92:95], v[172:175], v[128:143]
  v_lshlrev_b32 v230, 16, v240
  v_rcp_f32 v229, v230
  ds_read_b128 v[168:171], v12 offset:26624
  s_waitcnt lgkmcnt(5)
  v_mfma_f32_32x32x16_bf16 v[128:143], v[96:99], v[176:179], v[128:143]
  s_nop 0
  v_mul_f32 v229, s34, v229
  ds_write_b64 v9, v[228:229]
  ds_read_b128 v[172:175], v12 offset:27648
  v_mfma_f32_32x32x16_bf16 v[128:143], v[100:103], v[180:183], v[128:143]
  s_waitcnt lgkmcnt(1)
  s_barrier
  v_add_u32 v10, s42, v11
  ds_read_b64 v[208:209], v10
  v_add_u32 v10, s43, v11
  ds_read_b64 v[210:211], v10
  v_add_u32 v10, s44, v11
  ds_read_b64 v[212:213], v10
  v_add_u32 v10, s45, v11
  ds_read_b64 v[214:215], v10
  ds_read_b128 v[176:179], v4 offset:0
  v_mfma_f32_32x32x16_bf16 v[128:143], v[104:107], v[184:187], v[128:143]
  ds_read_b128 v[180:183], v4 offset:1024
  v_mfma_f32_32x32x16_bf16 v[128:143], v[108:111], v[188:191], v[128:143]
  ds_read_b128 v[184:187], v4 offset:2048
  v_mfma_f32_32x32x16_bf16 v[128:143], v[112:115], v[160:163], v[128:143]
  ds_read_b128 v[188:191], v4 offset:3072
  v_mfma_f32_32x32x16_bf16 v[128:143], v[116:119], v[164:167], v[128:143]
  s_waitcnt lgkmcnt(4)
  v_mov_b32 v200, v208
  v_mov_b32 v196, v210
  ds_read_b128 v[160:163], v4 offset:4096
  v_mfma_f32_32x32x16_bf16 v[128:143], v[120:123], v[168:171], v[128:143]
  ds_read_b128 v[164:167], v4 offset:5120
  v_mfma_f32_32x32x16_bf16 v[128:143], v[124:127], v[172:175], v[128:143]
  v_mfma_f32_32x32x16_bf16 v[128:143], v[192:195], v[200:203], v[128:143]
  v_mfma_f32_32x32x16_bf16 v[144:159], v[192:195], v[196:199], 0
  ds_read_b128 v[168:171], v4 offset:6144
  s_waitcnt lgkmcnt(5)
  v_mfma_f32_32x32x16_bf16 v[144:159], v[16:19], v[176:179], v[144:159]
  ds_read_b128 v[172:175], v4 offset:7168
  v_mfma_f32_32x32x16_bf16 v[144:159], v[20:23], v[180:183], v[144:159]
  s_barrier
  ds_read_b128 v[176:179], v4 offset:8192
  s_waitcnt lgkmcnt(5)
  v_mfma_f32_32x32x16_bf16 v[144:159], v[24:27], v[184:187], v[144:159]
  v_mul_f32 v128, v209, v128
  v_mul_f32 v129, v209, v129
  v_mul_f32 v130, v209, v130
  v_mul_f32 v131, v209, v131
  v_mul_f32 v132, v209, v132
  v_mul_f32 v133, v209, v133
  ds_read_b128 v[180:183], v4 offset:9216
  v_mfma_f32_32x32x16_bf16 v[144:159], v[28:31], v[188:191], v[144:159]
  v_mul_f32 v134, v209, v134
  v_mul_f32 v135, v209, v135
  v_exp_f32 v224, v128
  v_exp_f32 v225, v129
  ds_read_b128 v[184:187], v4 offset:10240
  s_waitcnt lgkmcnt(5)
  v_mfma_f32_32x32x16_bf16 v[144:159], v[32:35], v[160:163], v[144:159]
  v_exp_f32 v226, v130
  v_exp_f32 v227, v131
  v_exp_f32 v228, v132
  v_exp_f32 v229, v133
  ds_read_b128 v[188:191], v4 offset:11264
  v_mfma_f32_32x32x16_bf16 v[144:159], v[36:39], v[164:167], v[144:159]
  v_exp_f32 v230, v134
  v_exp_f32 v231, v135
  v_fma_f32 v224, v224, s34, s34
  v_fma_f32 v225, v225, s34, s34
  ds_read_b128 v[160:163], v4 offset:12288
  s_waitcnt lgkmcnt(5)
  v_mfma_f32_32x32x16_bf16 v[144:159], v[40:43], v[168:171], v[144:159]
  v_fma_f32 v226, v226, s34, s34
  v_fma_f32 v227, v227, s34, s34
  v_fma_f32 v228, v228, s34, s34
  v_fma_f32 v229, v229, s34, s34
  v_fma_f32 v230, v230, s34, s34
  v_fma_f32 v231, v231, s34, s34
  ds_read_b128 v[164:167], v4 offset:13312
  v_mfma_f32_32x32x16_bf16 v[144:159], v[44:47], v[172:175], v[144:159]
  v_rcp_f32 v224, v224
  v_rcp_f32 v225, v225
  v_rcp_f32 v226, v226
  ds_read_b128 v[168:171], v4 offset:14336
  s_waitcnt lgkmcnt(5)
  v_mfma_f32_32x32x16_bf16 v[144:159], v[48:51], v[176:179], v[144:159]
  v_rcp_f32 v227, v227
  v_rcp_f32 v228, v228
  v_rcp_f32 v229, v229
  ds_read_b128 v[172:175], v4 offset:15360
  v_mfma_f32_32x32x16_bf16 v[144:159], v[52:55], v[180:183], v[144:159]
  v_rcp_f32 v230, v230
  v_rcp_f32 v231, v231
  v_mul_f32 v128, v128, v224
  v_mul_f32 v129, v129, v225
  v_mul_f32 v130, v130, v226
  ds_read_b128 v[176:179], v4 offset:16384
  s_waitcnt lgkmcnt(5)
  v_mfma_f32_32x32x16_bf16 v[144:159], v[56:59], v[184:187], v[144:159]
  v_mul_f32 v131, v131, v227
  v_mul_f32 v132, v132, v228
  v_mul_f32 v133, v133, v229
  v_mul_f32 v134, v134, v230
  v_mul_f32 v135, v135, v231
  v_cvt_pk_bf16_f32 v240, v128, v129
  v_cvt_pk_bf16_f32 v241, v130, v131
  ds_read_b128 v[180:183], v4 offset:17408
  v_mfma_f32_32x32x16_bf16 v[144:159], v[60:63], v[188:191], v[144:159]
  v_cvt_pk_bf16_f32 v242, v132, v133
  v_cvt_pk_bf16_f32 v243, v134, v135
  buffer_store_dwordx4 v[240:243], v4, s[20:23], s36 offen offset:0
  v_mul_f32 v136, v209, v136
  v_mul_f32 v137, v209, v137
  v_mul_f32 v138, v209, v138
  ds_read_b128 v[184:187], v4 offset:18432
  s_waitcnt lgkmcnt(5)
  v_mfma_f32_32x32x16_bf16 v[144:159], v[64:67], v[160:163], v[144:159]
  v_mul_f32 v139, v209, v139
  v_mul_f32 v140, v209, v140
  v_mul_f32 v141, v209, v141
  v_mul_f32 v142, v209, v142
  v_mul_f32 v143, v209, v143
  v_exp_f32 v232, v136
  ds_read_b128 v[188:191], v4 offset:19456
  v_mfma_f32_32x32x16_bf16 v[144:159], v[68:71], v[164:167], v[144:159]
  v_exp_f32 v233, v137
  v_exp_f32 v234, v138
  v_exp_f32 v235, v139
  ds_read_b128 v[160:163], v4 offset:20480
  s_waitcnt lgkmcnt(5)
  v_mfma_f32_32x32x16_bf16 v[144:159], v[72:75], v[168:171], v[144:159]
  v_exp_f32 v236, v140
  v_exp_f32 v237, v141
  v_exp_f32 v238, v142
  ds_read_b128 v[164:167], v4 offset:21504
  v_mfma_f32_32x32x16_bf16 v[144:159], v[76:79], v[172:175], v[144:159]
  v_exp_f32 v239, v143
  v_fma_f32 v232, v232, s34, s34
  v_fma_f32 v233, v233, s34, s34
  v_fma_f32 v234, v234, s34, s34
  v_fma_f32 v235, v235, s34, s34
  v_fma_f32 v236, v236, s34, s34
  ds_read_b128 v[168:171], v4 offset:22528
  s_waitcnt lgkmcnt(5)
  v_mfma_f32_32x32x16_bf16 v[144:159], v[80:83], v[176:179], v[144:159]
  v_fma_f32 v237, v237, s34, s34
  v_fma_f32 v238, v238, s34, s34
  v_fma_f32 v239, v239, s34, s34
  v_rcp_f32 v232, v232
  v_rcp_f32 v233, v233
  ds_read_b128 v[172:175], v4 offset:23552
  v_mfma_f32_32x32x16_bf16 v[144:159], v[84:87], v[180:183], v[144:159]
  v_rcp_f32 v234, v234
  v_rcp_f32 v235, v235
  v_rcp_f32 v236, v236
  ds_read_b128 v[176:179], v4 offset:24576
  s_waitcnt lgkmcnt(5)
  v_mfma_f32_32x32x16_bf16 v[144:159], v[88:91], v[184:187], v[144:159]
  v_rcp_f32 v237, v237
  v_rcp_f32 v238, v238
  v_rcp_f32 v239, v239
  ds_read_b128 v[180:183], v4 offset:25600
  v_mfma_f32_32x32x16_bf16 v[144:159], v[92:95], v[188:191], v[144:159]
  v_mul_f32 v136, v136, v232
  v_mul_f32 v137, v137, v233
  v_mul_f32 v138, v138, v234
  v_mul_f32 v139, v139, v235
  v_mul_f32 v140, v140, v236
  v_mul_f32 v141, v141, v237
  v_mul_f32 v142, v142, v238
  ds_read_b128 v[184:187], v4 offset:26624
  s_waitcnt lgkmcnt(5)
  v_mfma_f32_32x32x16_bf16 v[144:159], v[96:99], v[160:163], v[144:159]
  v_mul_f32 v143, v143, v239
  v_cvt_pk_bf16_f32 v244, v136, v137
  v_cvt_pk_bf16_f32 v245, v138, v139
  v_cvt_pk_bf16_f32 v246, v140, v141
  v_cvt_pk_bf16_f32 v247, v142, v143
  buffer_store_dwordx4 v[244:247], v4, s[20:23], s36 offen offset:1024
  ds_read_b128 v[188:191], v4 offset:27648
  v_mfma_f32_32x32x16_bf16 v[144:159], v[100:103], v[164:167], v[144:159]
  s_barrier
  ds_read_b128 v[160:163], v4 offset:28672
  s_waitcnt lgkmcnt(5)
  v_mfma_f32_32x32x16_bf16 v[144:159], v[104:107], v[168:171], v[144:159]
  ds_read_b128 v[164:167], v4 offset:29696
  v_mfma_f32_32x32x16_bf16 v[144:159], v[108:111], v[172:175], v[144:159]
  ds_read_b128 v[168:171], v4 offset:30720
  s_waitcnt lgkmcnt(5)
  v_mfma_f32_32x32x16_bf16 v[144:159], v[112:115], v[176:179], v[144:159]
  ds_read_b128 v[172:175], v4 offset:31744
  v_mfma_f32_32x32x16_bf16 v[144:159], v[116:119], v[180:183], v[144:159]
  v_mov_b32 v196, v212
  ds_read_b128 v[176:179], v4 offset:32768
  s_waitcnt lgkmcnt(5)
  v_mfma_f32_32x32x16_bf16 v[144:159], v[120:123], v[184:187], v[144:159]
  ds_read_b128 v[180:183], v4 offset:33792
  v_mfma_f32_32x32x16_bf16 v[144:159], v[124:127], v[188:191], v[144:159]
  v_mfma_f32_32x32x16_bf16 v[128:143], v[192:195], v[196:199], 0
  ds_read_b128 v[184:187], v4 offset:34816
  s_waitcnt lgkmcnt(5)
  v_mfma_f32_32x32x16_bf16 v[128:143], v[16:19], v[160:163], v[128:143]
  ds_read_b128 v[188:191], v4 offset:35840
  v_mfma_f32_32x32x16_bf16 v[128:143], v[20:23], v[164:167], v[128:143]
  s_barrier
  ds_read_b128 v[160:163], v4 offset:36864
  s_waitcnt lgkmcnt(5)
  v_mfma_f32_32x32x16_bf16 v[128:143], v[24:27], v[168:171], v[128:143]
  s_waitcnt vmcnt(0)
  v_mov_b32 v14, 2
  s_cmp_lg_u32 s99, 0
  s_cbranch_scc1 L_ps_76
  buffer_store_dword v14, v15, s[20:23], s98 offen
L_pb_77:
  v_mul_f32 v144, v211, v144
  v_mul_f32 v145, v211, v145
  v_mul_f32 v146, v211, v146
  v_mul_f32 v147, v211, v147
  v_mul_f32 v148, v211, v148
  v_mul_f32 v149, v211, v149
  ds_read_b128 v[164:167], v4 offset:37888
  v_mfma_f32_32x32x16_bf16 v[128:143], v[28:31], v[172:175], v[128:143]
  v_mul_f32 v150, v211, v150
  v_mul_f32 v151, v211, v151
  v_exp_f32 v224, v144
  v_exp_f32 v225, v145
  ds_read_b128 v[168:171], v4 offset:38912
  s_waitcnt lgkmcnt(5)
  v_mfma_f32_32x32x16_bf16 v[128:143], v[32:35], v[176:179], v[128:143]
  v_exp_f32 v226, v146
  v_exp_f32 v227, v147
  v_exp_f32 v228, v148
  v_exp_f32 v229, v149
  ds_read_b128 v[172:175], v4 offset:39936
  v_mfma_f32_32x32x16_bf16 v[128:143], v[36:39], v[180:183], v[128:143]
  v_exp_f32 v230, v150
  v_exp_f32 v231, v151
  v_fma_f32 v224, v224, s34, s34
  v_fma_f32 v225, v225, s34, s34
  ds_read_b128 v[176:179], v4 offset:40960
  s_waitcnt lgkmcnt(5)
  v_mfma_f32_32x32x16_bf16 v[128:143], v[40:43], v[184:187], v[128:143]
  v_fma_f32 v226, v226, s34, s34
  v_fma_f32 v227, v227, s34, s34
  v_fma_f32 v228, v228, s34, s34
  v_fma_f32 v229, v229, s34, s34
  v_fma_f32 v230, v230, s34, s34
  v_fma_f32 v231, v231, s34, s34
  ds_read_b128 v[180:183], v4 offset:41984
  v_mfma_f32_32x32x16_bf16 v[128:143], v[44:47], v[188:191], v[128:143]
  v_rcp_f32 v224, v224
  v_rcp_f32 v225, v225
  v_rcp_f32 v226, v226
  ds_read_b128 v[184:187], v4 offset:43008
  s_waitcnt lgkmcnt(5)
  v_mfma_f32_32x32x16_bf16 v[128:143], v[48:51], v[160:163], v[128:143]
  v_rcp_f32 v227, v227
  v_rcp_f32 v228, v228
  v_rcp_f32 v229, v229
  ds_read_b128 v[188:191], v4 offset:44032
  v_mfma_f32_32x32x16_bf16 v[128:143], v[52:55], v[164:167], v[128:143]
  v_rcp_f32 v230, v230
  v_rcp_f32 v231, v231
  v_mul_f32 v144, v144, v224
  v_mul_f32 v145, v145, v225
  v_mul_f32 v146, v146, v226
  ds_read_b128 v[160:163], v4 offset:45056
  s_waitcnt lgkmcnt(5)
  v_mfma_f32_32x32x16_bf16 v[128:143], v[56:59], v[168:171], v[128:143]
  v_mul_f32 v147, v147, v227
  v_mul_f32 v148, v148, v228
  v_mul_f32 v149, v149, v229
  v_mul_f32 v150, v150, v230
  v_mul_f32 v151, v151, v231
  v_cvt_pk_bf16_f32 v240, v144, v145
  v_cvt_pk_bf16_f32 v241, v146, v147
  ds_read_b128 v[164:167], v4 offset:46080
  v_mfma_f32_32x32x16_bf16 v[128:143], v[60:63], v[172:175], v[128:143]
  v_cvt_pk_bf16_f32 v242, v148, v149
  v_cvt_pk_bf16_f32 v243, v150, v151
  buffer_store_dwordx4 v[240:243], v4, s[20:23], s37 offen offset:0
  v_mul_f32 v152, v211, v152
  v_mul_f32 v153, v211, v153
  v_mul_f32 v154, v211, v154
  ds_read_b128 v[168:171], v4 offset:47104
  s_waitcnt lgkmcnt(5)
  v_mfma_f32_32x32x16_bf16 v[128:143], v[64:67], v[176:179], v[128:143]
  v_mul_f32 v155, v211, v155
  v_mul_f32 v156, v211, v156
  v_mul_f32 v157, v211, v157
  v_mul_f32 v158, v211, v158
  v_mul_f32 v159, v211, v159
  v_exp_f32 v232, v152
  ds_read_b128 v[172:175], v4 offset:48128
  v_mfma_f32_32x32x16_bf16 v[128:143], v[68:71], v[180:183], v[128:143]
  v_exp_f32 v233, v153
  v_exp_f32 v234, v154
  v_exp_f32 v235, v155
  ds_read_b128 v[176:179], v4 offset:49152
  s_waitcnt lgkmcnt(5)
  v_mfma_f32_32x32x16_bf16 v[128:143], v[72:75], v[184:187], v[128:143]
  v_exp_f32 v236, v156
  v_exp_f32 v237, v157
  v_exp_f32 v238, v158
  ds_read_b128 v[180:183], v4 offset:50176
  v_mfma_f32_32x32x16_bf16 v[128:143], v[76:79], v[188:191], v[128:143]
  v_exp_f32 v239, v159
  v_fma_f32 v232, v232, s34, s34
  v_fma_f32 v233, v233, s34, s34
  v_fma_f32 v234, v234, s34, s34
  v_fma_f32 v235, v235, s34, s34
  v_fma_f32 v236, v236, s34, s34
  ds_read_b128 v[184:187], v4 offset:51200
  s_waitcnt lgkmcnt(5)
  v_mfma_f32_32x32x16_bf16 v[128:143], v[80:83], v[160:163], v[128:143]
  v_fma_f32 v237, v237, s34, s34
  v_fma_f32 v238, v238, s34, s34
  v_fma_f32 v239, v239, s34, s34
  v_rcp_f32 v232, v232
  v_rcp_f32 v233, v233
  ds_read_b128 v[188:191], v4 offset:52224
  v_mfma_f32_32x32x16_bf16 v[128:143], v[84:87], v[164:167], v[128:143]
  v_rcp_f32 v234, v234
  v_rcp_f32 v235, v235
  v_rcp_f32 v236, v236
  ds_read_b128 v[160:163], v4 offset:53248
  s_waitcnt lgkmcnt(5)
  v_mfma_f32_32x32x16_bf16 v[128:143], v[88:91], v[168:171], v[128:143]
  v_rcp_f32 v237, v237
  v_rcp_f32 v238, v238
  v_rcp_f32 v239, v239
  ds_read_b128 v[164:167], v4 offset:54272
  v_mfma_f32_32x32x16_bf16 v[128:143], v[92:95], v[172:175], v[128:143]
  v_mul_f32 v152, v152, v232
  v_mul_f32 v153, v153, v233
  v_mul_f32 v154, v154, v234
  v_mul_f32 v155, v155, v235
  v_mul_f32 v156, v156, v236
  v_mul_f32 v157, v157, v237
  v_mul_f32 v158, v158, v238
  ds_read_b128 v[168:171], v4 offset:55296
  s_waitcnt lgkmcnt(5)
  v_mfma_f32_32x32x16_bf16 v[128:143], v[96:99], v[176:179], v[128:143]
  v_mul_f32 v159, v159, v239
  v_cvt_pk_bf16_f32 v244, v152, v153
  v_cvt_pk_bf16_f32 v245, v154, v155
  v_cvt_pk_bf16_f32 v246, v156, v157
  v_cvt_pk_bf16_f32 v247, v158, v159
  buffer_store_dwordx4 v[244:247], v4, s[20:23], s37 offen offset:1024
  ds_read_b128 v[172:175], v4 offset:56320
  v_mfma_f32_32x32x16_bf16 v[128:143], v[100:103], v[180:183], v[128:143]
  ds_read_b128 v[176:179], v13 offset:0
  s_waitcnt lgkmcnt(5)
  v_mfma_f32_32x32x16_bf16 v[128:143], v[104:107], v[184:187], v[128:143]
  ds_read_b128 v[180:183], v13 offset:1024
  v_mfma_f32_32x32x16_bf16 v[128:143], v[108:111], v[188:191], v[128:143]
  ds_read_b128 v[184:187], v13 offset:2048
  s_waitcnt lgkmcnt(5)
  v_mfma_f32_32x32x16_bf16 v[128:143], v[112:115], v[160:163], v[128:143]
  ds_read_b128 v[188:191], v13 offset:3072
  v_mfma_f32_32x32x16_bf16 v[128:143], v[116:119], v[164:167], v[128:143]
  v_mov_b32 v196, v214
  ds_read_b128 v[160:163], v13 offset:4096
  s_waitcnt lgkmcnt(5)
  v_mfma_f32_32x32x16_bf16 v[128:143], v[120:123], v[168:171], v[128:143]
  ds_read_b128 v[164:167], v13 offset:5120
  v_mfma_f32_32x32x16_bf16 v[128:143], v[124:127], v[172:175], v[128:143]
  v_mfma_f32_32x32x16_bf16 v[144:159], v[192:195], v[196:199], 0
  ds_read_b128 v[168:171], v13 offset:6144
  s_waitcnt lgkmcnt(5)
  v_mfma_f32_32x32x16_bf16 v[144:159], v[16:19], v[176:179], v[144:159]
  ds_read_b128 v[172:175], v13 offset:7168
  v_mfma_f32_32x32x16_bf16 v[144:159], v[20:23], v[180:183], v[144:159]
  ds_read_b128 v[176:179], v13 offset:8192
  s_waitcnt lgkmcnt(5)
  v_mfma_f32_32x32x16_bf16 v[144:159], v[24:27], v[184:187], v[144:159]
  s_waitcnt vmcnt(0)
  v_mov_b32 v14, 3
  s_cmp_lg_u32 s99, 0
  s_cbranch_scc1 L_ps_78
  buffer_store_dword v14, v15, s[20:23], s98 offen
L_pb_79:
  v_mul_f32 v128, v213, v128
  v_mul_f32 v129, v213, v129
  v_mul_f32 v130, v213, v130
  v_mul_f32 v131, v213, v131
  v_mul_f32 v132, v213, v132
  v_mul_f32 v133, v213, v133
  ds_read_b128 v[180:183], v13 offset:9216
  v_mfma_f32_32x32x16_bf16 v[144:159], v[28:31], v[188:191], v[144:159]
  v_mul_f32 v134, v213, v134
  v_mul_f32 v135, v213, v135
  v_exp_f32 v224, v128
  v_exp_f32 v225, v129
  ds_read_b128 v[184:187], v13 offset:10240
  s_waitcnt lgkmcnt(5)
  v_mfma_f32_32x32x16_bf16 v[144:159], v[32:35], v[160:163], v[144:159]
  v_exp_f32 v226, v130
  v_exp_f32 v227, v131
  v_exp_f32 v228, v132
  v_exp_f32 v229, v133
  ds_read_b128 v[188:191], v13 offset:11264
  v_mfma_f32_32x32x16_bf16 v[144:159], v[36:39], v[164:167], v[144:159]
  v_exp_f32 v230, v134
  v_exp_f32 v231, v135
  v_fma_f32 v224, v224, s34, s34
  v_fma_f32 v225, v225, s34, s34
  ds_read_b128 v[160:163], v13 offset:12288
  s_waitcnt lgkmcnt(5)
  v_mfma_f32_32x32x16_bf16 v[144:159], v[40:43], v[168:171], v[144:159]
  v_fma_f32 v226, v226, s34, s34
  v_fma_f32 v227, v227, s34, s34
  v_fma_f32 v228, v228, s34, s34
  v_fma_f32 v229, v229, s34, s34
  v_fma_f32 v230, v230, s34, s34
  v_fma_f32 v231, v231, s34, s34
  ds_read_b128 v[164:167], v13 offset:13312
  v_mfma_f32_32x32x16_bf16 v[144:159], v[44:47], v[172:175], v[144:159]
  v_rcp_f32 v224, v224
  v_rcp_f32 v225, v225
  v_rcp_f32 v226, v226
  ds_read_b128 v[168:171], v13 offset:14336
  s_waitcnt lgkmcnt(5)
  v_mfma_f32_32x32x16_bf16 v[144:159], v[48:51], v[176:179], v[144:159]
  v_rcp_f32 v227, v227
  v_rcp_f32 v228, v228
  v_rcp_f32 v229, v229
  ds_read_b128 v[172:175], v13 offset:15360
  v_mfma_f32_32x32x16_bf16 v[144:159], v[52:55], v[180:183], v[144:159]
  v_rcp_f32 v230, v230
  v_rcp_f32 v231, v231
  v_mul_f32 v128, v128, v224
  v_mul_f32 v129, v129, v225
  v_mul_f32 v130, v130, v226
  ds_read_b128 v[176:179], v13 offset:16384
  s_waitcnt lgkmcnt(5)
  v_mfma_f32_32x32x16_bf16 v[144:159], v[56:59], v[184:187], v[144:159]
  v_mul_f32 v131, v131, v227
  v_mul_f32 v132, v132, v228
  v_mul_f32 v133, v133, v229
  v_mul_f32 v134, v134, v230
  v_mul_f32 v135, v135, v231
  v_cvt_pk_bf16_f32 v240, v128, v129
  v_cvt_pk_bf16_f32 v241, v130, v131
  ds_read_b128 v[180:183], v13 offset:17408
  v_mfma_f32_32x32x16_bf16 v[144:159], v[60:63], v[188:191], v[144:159]
  v_cvt_pk_bf16_f32 v242, v132, v133
  v_cvt_pk_bf16_f32 v243, v134, v135
  buffer_store_dwordx4 v[240:243], v4, s[20:23], s38 offen offset:0
  v_mul_f32 v136, v213, v136
  v_mul_f32 v137, v213, v137
  v_mul_f32 v138, v213, v138
  ds_read_b128 v[184:187], v13 offset:18432
  s_waitcnt lgkmcnt(5)
  v_mfma_f32_32x32x16_bf16 v[144:159], v[64:67], v[160:163], v[144:159]
  v_mul_f32 v139, v213, v139
  v_mul_f32 v140, v213, v140
  v_mul_f32 v141, v213, v141
  v_mul_f32 v142, v213, v142
  v_mul_f32 v143, v213, v143
  v_exp_f32 v232, v136
  ds_read_b128 v[188:191], v13 offset:19456
  v_mfma_f32_32x32x16_bf16 v[144:159], v[68:71], v[164:167], v[144:159]
  v_exp_f32 v233, v137
  v_exp_f32 v234, v138
  v_exp_f32 v235, v139
  ds_read_b128 v[160:163], v13 offset:20480
  s_waitcnt lgkmcnt(5)
  v_mfma_f32_32x32x16_bf16 v[144:159], v[72:75], v[168:171], v[144:159]
  v_exp_f32 v236, v140
  v_exp_f32 v237, v141
  v_exp_f32 v238, v142
  ds_read_b128 v[164:167], v13 offset:21504
  v_mfma_f32_32x32x16_bf16 v[144:159], v[76:79], v[172:175], v[144:159]
  v_exp_f32 v239, v143
  v_fma_f32 v232, v232, s34, s34
  v_fma_f32 v233, v233, s34, s34
  v_fma_f32 v234, v234, s34, s34
  v_fma_f32 v235, v235, s34, s34
  v_fma_f32 v236, v236, s34, s34
  ds_read_b128 v[168:171], v13 offset:22528
  s_waitcnt lgkmcnt(5)
  v_mfma_f32_32x32x16_bf16 v[144:159], v[80:83], v[176:179], v[144:159]
  v_fma_f32 v237, v237, s34, s34
  v_fma_f32 v238, v238, s34, s34
  v_fma_f32 v239, v239, s34, s34
  v_rcp_f32 v232, v232
  v_rcp_f32 v233, v233
  ds_read_b128 v[172:175], v13 offset:23552
  v_mfma_f32_32x32x16_bf16 v[144:159], v[84:87], v[180:183], v[144:159]
  v_rcp_f32 v234, v234
  v_rcp_f32 v235, v235
  v_rcp_f32 v236, v236
  ds_read_b128 v[176:179], v13 offset:24576
  s_waitcnt lgkmcnt(5)
  v_mfma_f32_32x32x16_bf16 v[144:159], v[88:91], v[184:187], v[144:159]
  v_rcp_f32 v237, v237
  v_rcp_f32 v238, v238
  v_rcp_f32 v239, v239
  ds_read_b128 v[180:183], v13 offset:25600
  v_mfma_f32_32x32x16_bf16 v[144:159], v[92:95], v[188:191], v[144:159]
  v_mul_f32 v136, v136, v232
  v_mul_f32 v137, v137, v233
  v_mul_f32 v138, v138, v234
  v_mul_f32 v139, v139, v235
  v_mul_f32 v140, v140, v236
  v_mul_f32 v141, v141, v237
  v_mul_f32 v142, v142, v238
  ds_read_b128 v[184:187], v13 offset:26624
  s_waitcnt lgkmcnt(5)
  v_mfma_f32_32x32x16_bf16 v[144:159], v[96:99], v[160:163], v[144:159]
  v_mul_f32 v143, v143, v239
  v_cvt_pk_bf16_f32 v244, v136, v137
  v_cvt_pk_bf16_f32 v245, v138, v139
  v_cvt_pk_bf16_f32 v246, v140, v141
  v_cvt_pk_bf16_f32 v247, v142, v143
  buffer_store_dwordx4 v[244:247], v4, s[20:23], s38 offen offset:1024
  ds_read_b128 v[188:191], v13 offset:27648
  v_mfma_f32_32x32x16_bf16 v[144:159], v[100:103], v[164:167], v[144:159]
  s_waitcnt lgkmcnt(4)
  v_mfma_f32_32x32x16_bf16 v[144:159], v[104:107], v[168:171], v[144:159]
  v_mfma_f32_32x32x16_bf16 v[144:159], v[108:111], v[172:175], v[144:159]
  s_waitcnt lgkmcnt(2)
  v_mfma_f32_32x32x16_bf16 v[144:159], v[112:115], v[176:179], v[144:159]
  v_mfma_f32_32x32x16_bf16 v[144:159], v[116:119], v[180:183], v[144:159]
  s_waitcnt lgkmcnt(0)
  v_mfma_f32_32x32x16_bf16 v[144:159], v[120:123], v[184:187], v[144:159]
  v_mfma_f32_32x32x16_bf16 v[144:159], v[124:127], v[188:191], v[144:159]
  s_nop 7
  s_nop 3
  v_mul_f32 v144, v215, v144
  v_mul_f32 v145, v215, v145
  v_mul_f32 v146, v215, v146
  v_mul_f32 v147, v215, v147
  v_mul_f32 v148, v215, v148
  v_mul_f32 v149, v215, v149
  v_mul_f32 v150, v215, v150
  v_mul_f32 v151, v215, v151
  v_exp_f32 v224, v144
  v_exp_f32 v225, v145
  v_exp_f32 v226, v146
  v_exp_f32 v227, v147
  v_exp_f32 v228, v148
  s_waitcnt vmcnt(0)
  v_mov_b32 v14, 4
  s_cmp_lg_u32 s99, 0
  s_cbranch_scc1 L_ps_80
  buffer_store_dword v14, v15, s[20:23], s98 offen
L_pb_81:
  v_exp_f32 v229, v149
  v_exp_f32 v230, v150
  v_exp_f32 v231, v151
  v_fma_f32 v224, v224, s34, s34
  v_fma_f32 v225, v225, s34, s34
  v_fma_f32 v226, v226, s34, s34
  v_fma_f32 v227, v227, s34, s34
  v_fma_f32 v228, v228, s34, s34
  v_fma_f32 v229, v229, s34, s34
  v_fma_f32 v230, v230, s34, s34
  v_fma_f32 v231, v231, s34, s34
  v_rcp_f32 v224, v224
  v_rcp_f32 v225, v225
  v_rcp_f32 v226, v226
  v_rcp_f32 v227, v227
  v_rcp_f32 v228, v228
  v_rcp_f32 v229, v229
  v_rcp_f32 v230, v230
  v_rcp_f32 v231, v231
  v_mul_f32 v144, v144, v224
  v_mul_f32 v145, v145, v225
  v_mul_f32 v146, v146, v226
  v_mul_f32 v147, v147, v227
  v_mul_f32 v148, v148, v228
  v_mul_f32 v149, v149, v229
  v_mul_f32 v150, v150, v230
  v_mul_f32 v151, v151, v231
  v_cvt_pk_bf16_f32 v240, v144, v145
  v_cvt_pk_bf16_f32 v241, v146, v147
  v_cvt_pk_bf16_f32 v242, v148, v149
  v_cvt_pk_bf16_f32 v243, v150, v151
  buffer_store_dwordx4 v[240:243], v4, s[20:23], s39 offen offset:0
  v_mul_f32 v152, v215, v152
  v_mul_f32 v153, v215, v153
  v_mul_f32 v154, v215, v154
  v_mul_f32 v155, v215, v155
  v_mul_f32 v156, v215, v156
  v_mul_f32 v157, v215, v157
  v_mul_f32 v158, v215, v158
  v_mul_f32 v159, v215, v159
  v_exp_f32 v232, v152
  v_exp_f32 v233, v153
  v_exp_f32 v234, v154
  v_exp_f32 v235, v155
  v_exp_f32 v236, v156
  v_exp_f32 v237, v157
  v_exp_f32 v238, v158
  v_exp_f32 v239, v159
  v_fma_f32 v232, v232, s34, s34
  v_fma_f32 v233, v233, s34, s34
  v_fma_f32 v234, v234, s34, s34
  v_fma_f32 v235, v235, s34, s34
  v_fma_f32 v236, v236, s34, s34
  v_fma_f32 v237, v237, s34, s34
  v_fma_f32 v238, v238, s34, s34
  v_fma_f32 v239, v239, s34, s34
  v_rcp_f32 v232, v232
  v_rcp_f32 v233, v233
  v_rcp_f32 v234, v234
  v_rcp_f32 v235, v235
  v_rcp_f32 v236, v236
  v_rcp_f32 v237, v237
  v_rcp_f32 v238, v238
  v_rcp_f32 v239, v239
  v_mul_f32 v152, v152, v232
  v_mul_f32 v153, v153, v233
  v_mul_f32 v154, v154, v234
  v_mul_f32 v155, v155, v235
  v_mul_f32 v156, v156, v236
  v_mul_f32 v157, v157, v237
  v_mul_f32 v158, v158, v238
  v_mul_f32 v159, v159, v239
  v_cvt_pk_bf16_f32 v244, v152, v153
  v_cvt_pk_bf16_f32 v245, v154, v155
  v_cvt_pk_bf16_f32 v246, v156, v157
  v_cvt_pk_bf16_f32 v247, v158, v159
  buffer_store_dwordx4 v[244:247], v4, s[20:23], s39 offen offset:1024
  s_waitcnt vmcnt(0)
  v_mov_b32 v14, 5
  s_cmp_lg_u32 s99, 0
  s_cbranch_scc1 L_ps_82
  buffer_store_dword v14, v15, s[20:23], s98 offen
L_pb_83:
  s_branch L_m_fin
L_m_lnon:
  s_sleep 32
  buffer_load_dword v225, v5, s[32:35], s47 offen
  s_add_u32 s47, s47, 1048576
  s_waitcnt vmcnt(0)
  buffer_load_dword v226, v5, s[32:35], s47 offen
  s_add_u32 s47, s47, 1048576
  s_waitcnt vmcnt(0)
L_m_fin:
L_m_end:
  s_endpgm
L_ps_1:
  buffer_wbl2 sc1
  s_waitcnt vmcnt(0)
  v_mov_b32 v10, 2
  buffer_store_dword v10, v47, s[20:23], s50 offen sc1
  s_branch L_pb_2
L_fw_3:
  buffer_load_dword v10, v15, s[20:23], s51 offen sc1
  s_waitcnt vmcnt(0)
  v_cmp_lt_u32 vcc, 1, v10
  s_or_b32 s58, vcc_lo, s99
  s_cbranch_scc1 L_fo_4
  v_cmp_eq_u32 vcc, 1, v10
  s_lshr_b32 s57, vcc_lo, 16
  s_and_b32 s57, s57, vcc_lo
  s_andn2_b32 s58, s56, s57
  s_cbranch_scc0 L_m_main
  s_sub_u32 s100, s100, 1
  s_cbranch_scc0 L_fw_3
  s_mov_b32 s100, 0
  s_branch L_m_main
L_fo_4:
  s_mov_b32 s99, 1
  buffer_wbl2 sc1
  v_mov_b32 v9, 159748
  v_mov_b32 v10, 1
  ds_write_b32 v9, v10
  s_waitcnt vmcnt(0)
L_ft_5:
  buffer_load_dword v10, v15, s[20:23], s51 offen sc1
  s_waitcnt vmcnt(0)
  v_cmp_le_u32 vcc, 1, v10
  s_cmp_eq_u64 vcc, exec
  s_cbranch_scc1 L_ft_5d
  s_sub_u32 s100, s100, 1
  s_cbranch_scc0 L_ft_5
  s_mov_b32 s100, 0
L_ft_5d:
  buffer_inv sc1
  s_mov_b32 s57, -1
  s_mov_b32 s59, -1
  s_waitcnt vmcnt(0)
  s_branch L_m_main
L_ke_7:
  s_lshl_b32 s56, 1, s56
L_fw_8:
  buffer_load_dword v10, v15, s[20:23], s51 offen sc1
  s_waitcnt vmcnt(0)
  v_cmp_lt_u32 vcc, 1, v10
  s_or_b32 s58, vcc_lo, s99
  s_cbranch_scc1 L_fo_9
  v_cmp_eq_u32 vcc, 1, v10
  s_lshr_b32 s57, vcc_lo, 16
  s_and_b32 s57, s57, vcc_lo
  s_andn2_b32 s58, s56, s57
  s_cbranch_scc0 L_kc_6
  s_sub_u32 s100, s100, 1
  s_cbranch_scc0 L_fw_8
  s_mov_b32 s100, 0
  s_branch L_kc_6
L_fo_9:
  s_mov_b32 s99, 1
  buffer_wbl2 sc1
  v_mov_b32 v9, 159748
  v_mov_b32 v10, 1
  ds_write_b32 v9, v10
  s_waitcnt vmcnt(0)
L_ft_10:
  buffer_load_dword v10, v15, s[20:23], s51 offen sc1
  s_waitcnt vmcnt(0)
  v_cmp_le_u32 vcc, 1, v10
  s_cmp_eq_u64 vcc, exec
  s_cbranch_scc1 L_ft_10d
  s_sub_u32 s100, s100, 1
  s_cbranch_scc0 L_ft_10
  s_mov_b32 s100, 0
L_ft_10d:
  buffer_inv sc1
  s_mov_b32 s57, -1
  s_mov_b32 s59, -1
  s_waitcnt vmcnt(0)
  s_branch L_kc_6
L_ke_12:
  s_lshl_b32 s56, 1, s56
L_fw_13:
  buffer_load_dword v10, v15, s[20:23], s51 offen sc1
  s_waitcnt vmcnt(0)
  v_cmp_lt_u32 vcc, 1, v10
  s_or_b32 s58, vcc_lo, s99
  s_cbranch_scc1 L_fo_14
  v_cmp_eq_u32 vcc, 1, v10
  s_lshr_b32 s57, vcc_lo, 16
  s_and_b32 s57, s57, vcc_lo
  s_andn2_b32 s58, s56, s57
  s_cbranch_scc0 L_kc_11
  s_sub_u32 s100, s100, 1
  s_cbranch_scc0 L_fw_13
  s_mov_b32 s100, 0
  s_branch L_kc_11
L_fo_14:
  s_mov_b32 s99, 1
  buffer_wbl2 sc1
  v_mov_b32 v9, 159748
  v_mov_b32 v10, 1
  ds_write_b32 v9, v10
  s_waitcnt vmcnt(0)
L_ft_15:
  buffer_load_dword v10, v15, s[20:23], s51 offen sc1
  s_waitcnt vmcnt(0)
  v_cmp_le_u32 vcc, 1, v10
  s_cmp_eq_u64 vcc, exec
  s_cbranch_scc1 L_ft_15d
  s_sub_u32 s100, s100, 1
  s_cbranch_scc0 L_ft_15
  s_mov_b32 s100, 0
L_ft_15d:
  buffer_inv sc1
  s_mov_b32 s57, -1
  s_mov_b32 s59, -1
  s_waitcnt vmcnt(0)
  s_branch L_kc_11
L_ke_17:
  s_lshl_b32 s56, 1, s56
L_fw_18:
  buffer_load_dword v10, v15, s[20:23], s51 offen sc1
  s_waitcnt vmcnt(0)
  v_cmp_lt_u32 vcc, 1, v10
  s_or_b32 s58, vcc_lo, s99
  s_cbranch_scc1 L_fo_19
  v_cmp_eq_u32 vcc, 1, v10
  s_lshr_b32 s57, vcc_lo, 16
  s_and_b32 s57, s57, vcc_lo
  s_andn2_b32 s58, s56, s57
  s_cbranch_scc0 L_kc_16
  s_sub_u32 s100, s100, 1
  s_cbranch_scc0 L_fw_18
  s_mov_b32 s100, 0
  s_branch L_kc_16
L_fo_19:
  s_mov_b32 s99, 1
  buffer_wbl2 sc1
  v_mov_b32 v9, 159748
  v_mov_b32 v10, 1
  ds_write_b32 v9, v10
  s_waitcnt vmcnt(0)
L_ft_20:
  buffer_load_dword v10, v15, s[20:23], s51 offen sc1
  s_waitcnt vmcnt(0)
  v_cmp_le_u32 vcc, 1, v10
  s_cmp_eq_u64 vcc, exec
  s_cbranch_scc1 L_ft_20d
  s_sub_u32 s100, s100, 1
  s_cbranch_scc0 L_ft_20
  s_mov_b32 s100, 0
L_ft_20d:
  buffer_inv sc1
  s_mov_b32 s57, -1
  s_mov_b32 s59, -1
  s_waitcnt vmcnt(0)
  s_branch L_kc_16
L_ke_22:
  s_lshl_b32 s56, 1, s56
L_fw_23:
  buffer_load_dword v10, v15, s[20:23], s51 offen sc1
  s_waitcnt vmcnt(0)
  v_cmp_lt_u32 vcc, 1, v10
  s_or_b32 s58, vcc_lo, s99
  s_cbranch_scc1 L_fo_24
  v_cmp_eq_u32 vcc, 1, v10
  s_lshr_b32 s57, vcc_lo, 16
  s_and_b32 s57, s57, vcc_lo
  s_andn2_b32 s58, s56, s57
  s_cbranch_scc0 L_kc_21
  s_sub_u32 s100, s100, 1
  s_cbranch_scc0 L_fw_23
  s_mov_b32 s100, 0
  s_branch L_kc_21
L_fo_24:
  s_mov_b32 s99, 1
  buffer_wbl2 sc1
  v_mov_b32 v9, 159748
  v_mov_b32 v10, 1
  ds_write_b32 v9, v10
  s_waitcnt vmcnt(0)
L_ft_25:
  buffer_load_dword v10, v15, s[20:23], s51 offen sc1
  s_waitcnt vmcnt(0)
  v_cmp_le_u32 vcc, 1, v10
  s_cmp_eq_u64 vcc, exec
  s_cbranch_scc1 L_ft_25d
  s_sub_u32 s100, s100, 1
  s_cbranch_scc0 L_ft_25
  s_mov_b32 s100, 0
L_ft_25d:
  buffer_inv sc1
  s_mov_b32 s57, -1
  s_mov_b32 s59, -1
  s_waitcnt vmcnt(0)
  s_branch L_kc_21
L_ke_27:
  s_lshl_b32 s56, 1, s56
L_fw_28:
  buffer_load_dword v10, v15, s[20:23], s51 offen sc1
  s_waitcnt vmcnt(0)
  v_cmp_lt_u32 vcc, 1, v10
  s_or_b32 s58, vcc_lo, s99
  s_cbranch_scc1 L_fo_29
  v_cmp_eq_u32 vcc, 1, v10
  s_lshr_b32 s57, vcc_lo, 16
  s_and_b32 s57, s57, vcc_lo
  s_andn2_b32 s58, s56, s57
  s_cbranch_scc0 L_kc_26
  s_sub_u32 s100, s100, 1
  s_cbranch_scc0 L_fw_28
  s_mov_b32 s100, 0
  s_branch L_kc_26
L_fo_29:
  s_mov_b32 s99, 1
  buffer_wbl2 sc1
  v_mov_b32 v9, 159748
  v_mov_b32 v10, 1
  ds_write_b32 v9, v10
  s_waitcnt vmcnt(0)
L_ft_30:
  buffer_load_dword v10, v15, s[20:23], s51 offen sc1
  s_waitcnt vmcnt(0)
  v_cmp_le_u32 vcc, 1, v10
  s_cmp_eq_u64 vcc, exec
  s_cbranch_scc1 L_ft_30d
  s_sub_u32 s100, s100, 1
  s_cbranch_scc0 L_ft_30
  s_mov_b32 s100, 0
L_ft_30d:
  buffer_inv sc1
  s_mov_b32 s57, -1
  s_mov_b32 s59, -1
  s_waitcnt vmcnt(0)
  s_branch L_kc_26
L_ps_31:
  buffer_store_dword v9, v8, s[20:23], s52 offen sc1
  s_branch L_pb_32
L_ps_35:
  buffer_wbl2 sc1
  s_waitcnt vmcnt(0)
  buffer_store_dword v14, v15, s[20:23], s98 offen sc1
  s_branch L_pb_36
L_m_cen2:
  s_sub_u32 s100, s100, 1
  s_cbranch_scc1 L_m_cento
  s_sleep 16
  buffer_load_dwordx2 v[30:31], off, s[52:55], 0 sc1
  s_waitcnt vmcnt(0)
  s_branch L_m_cen
L_m_cento:
  s_mov_b32 s100, 0
  s_branch L_m_cenok
L_ps_76:
  buffer_wbl2 sc1
  s_waitcnt vmcnt(0)
  buffer_store_dword v14, v15, s[20:23], s98 offen sc1
  s_branch L_pb_77
L_ps_78:
  buffer_wbl2 sc1
  s_waitcnt vmcnt(0)
  buffer_store_dword v14, v15, s[20:23], s98 offen sc1
  s_branch L_pb_79
L_ps_80:
  buffer_wbl2 sc1
  s_waitcnt vmcnt(0)
  buffer_store_dword v14, v15, s[20:23], s98 offen sc1
  s_branch L_pb_81
L_ps_82:
  buffer_wbl2 sc1
  s_waitcnt vmcnt(0)
  buffer_store_dword v14, v15, s[20:23], s98 offen sc1
  s_branch L_pb_83
.section .rodata,"a"
.p2align 6
.amdhsa_kernel mega_kernel
  .amdhsa_next_free_vgpr 256
  .amdhsa_next_free_sgpr 102
  .amdhsa_accum_offset 256
  .amdhsa_group_segment_fixed_size 0
  .amdhsa_kernarg_size 72
  .amdhsa_user_sgpr_count 2
  .amdhsa_user_sgpr_kernarg_segment_ptr 1
  .amdhsa_system_sgpr_workgroup_id_x 1
.end_amdhsa_kernel
```
